```python
import torch

def _softmax(x, axis=-1):
    return torch.softmax(x, dim=axis)
def _gelu(x):
    return torch.nn.functional.gelu(x, approximate="tanh")
def _silu(x):
    return torch.nn.functional.silu(x)
def _sigmoid(x):
    return torch.sigmoid(x)
def _layernorm(x, axis=-1, eps=1e-5):
    m = x.mean(dim=axis, keepdim=True)
    v = x.var(dim=axis, keepdim=True, unbiased=False)
    return (x - m) / torch.sqrt(v + eps)
def _scatter_add(tgt, idx, src, axis=0):
    return tgt.clone().index_add_(axis, idx, src)
def _segment_sum(src, seg, n):
    out = torch.zeros((n,) + src.shape[1:], dtype=src.dtype)
    return out.index_add_(0, seg, src)
def _pad(x, pw):
    flat = tuple(v for pair in reversed(pw) for v in pair)
    return torch.nn.functional.pad(x, flat)

kernel_name = 'interleave_layers__ssm_conv_h3__glu_gated_swiglu__prompt'

def setup_inputs():

    _w = (lambda a: (lambda t: t.to(torch.bfloat16) if t.is_floating_point() else t)(torch.as_tensor(a)))
    def _A_setup():
        B, S, D = 1, 2048, 512
        ks = 4
        return {
            "q": _w((lambda *s: torch.randn(*s, dtype=torch.bfloat16) * 0.05)(B, S, D)),
            "k": _w((lambda *s: torch.randn(*s, dtype=torch.bfloat16) * 0.2)(B, S, D)),
            "v": _w((lambda *s: torch.randn(*s, dtype=torch.bfloat16) * 0.2)(B, S, D)),
            "shift_k": _w((lambda *s: torch.randn(*s, dtype=torch.bfloat16) * 0.2)(D, ks) * 0.5),
            "ssm_k": _w((lambda *s: torch.randn(*s, dtype=torch.bfloat16) * 0.4)(D, S) * (1.0 / S ** 0.5)),
            "ssm_D": _w((lambda *s: torch.randn(*s, dtype=torch.bfloat16) * 0.2)(D)),
        }
    _A_in = _A_setup()

    def _B_setup():
        B, S, D, F = 1, 2048, 512, 1376
        return {
            "x": _w((lambda *s: torch.randn(*s, dtype=torch.bfloat16) * 0.05)(B, S, D)),
            "w1": _w((lambda *s: torch.randn(*s, dtype=torch.bfloat16) * 0.2)(D, F) * (2.0 / D) ** 0.5),
            "w3": _w((lambda *s: torch.randn(*s, dtype=torch.bfloat16) * 0.2)(D, F) * (2.0 / D) ** 0.5),
            "w2": _w((lambda *s: torch.randn(*s, dtype=torch.bfloat16) * 0.2)(F, D) * (2.0 / F) ** 0.5),
        }
    _B_in = _B_setup()

    return {
        "A_q": _A_in["q"],
        "A_k": _A_in["k"],
        "A_v": _A_in["v"],
        "A_shift_k": _A_in["shift_k"],
        "A_ssm_k": _A_in["ssm_k"],
        "A_ssm_D": _A_in["ssm_D"],
        "B_x": _B_in["x"],
        "B_w1": _B_in["w1"],
        "B_w3": _B_in["w3"],
        "B_w2": _B_in["w2"],
    }

def reference(A_q, A_k, A_v, A_shift_k, A_ssm_k, A_ssm_D, B_x, B_w1, B_w3, B_w2):
    def _A_ref(q, k, v, shift_k, ssm_k, ssm_D):
        B, S, D = q.shape
        ks = shift_k.shape[-1]
        k_pad = _pad(k, ((0, 0), (ks - 1, 0), (0, 0)))
        k_shift = torch.zeros_like(k)
        for t in range(ks):
            k_shift = k_shift + k_pad[:, t:t + S, :] * shift_k[:, ks - 1 - t][None, None, :]
        kv = k_shift * v
        L = 2 * S
        kv_pad = _pad(kv, ((0, 0), (0, S), (0, 0)))
        kf_pad = _pad(ssm_k, ((0, 0), (0, S)))
        kv_f = (lambda x, axes=(-2,-1): torch.fft.rfft2(x.float(), dim=axes))(kv_pad[:, None, :, :], axes=(1, 2))
        kf_f = (lambda x, axes=(-2,-1): torch.fft.rfft2(x.float(), dim=axes))(kf_pad[:, None, :], axes=(1, 2))
        kf_f = (lambda x, *d: x.permute(*d))(kf_f, 1, 2, 0)
        y_f = kv_f * kf_f[None, :, :, :]
        y = (lambda x, s, axes=(-2,-1): torch.fft.irfft2(x, s=s, dim=axes).to(torch.bfloat16))(y_f, (1, L), axes=(1, 2))[:, 0, :S, :]
        y = y + kv * ssm_D[None, None, :]
        return q * y

    def _B_ref(x, w1, w3, w2):
        gate = torch.einsum("bsd,df->bsf", x, w1)
        up = torch.einsum("bsd,df->bsf", x, w3)
        h = _silu(gate) * up
        out = torch.einsum("bsf,fd->bsd", h, w2)
        return out

    x = A_q
    x = x + _A_ref(_layernorm(x, axis=-1), A_k, A_v, A_shift_k, A_ssm_k, A_ssm_D)
    x = x + _B_ref(_layernorm(x, axis=-1), B_w1, B_w3, B_w2)
    x = x + _A_ref(_layernorm(x, axis=-1), A_k, A_v, A_shift_k, A_ssm_k, A_ssm_D)
    x = x + _B_ref(_layernorm(x, axis=-1), B_w1, B_w3, B_w2)
    return x
```

```asm
; @launch kernel=p1_conv_kernel grid=(256,1,1) block=(512,1,1) lds=65536
; @launch kernel=interleave_layers__ssm_conv_h3__glu_gated_swiglu__prompt_kernel grid=(256,1,1) block=(256,1,1) lds=163840
.amdgcn_target "amdgcn-amd-amdhsa--gfx950"
.text
.globl p1_conv_kernel
.p2align 8
.type p1_conv_kernel,@function
p1_conv_kernel:
    s_cmp_ge_u32 s2, 256
    s_cbranch_scc1 L_end
    s_load_dwordx2 s[16:17], s[0:1], 8
    s_load_dwordx2 s[20:21], s[0:1], 16
    s_getpc_b64 s[56:57]
L_pc1:
    s_add_u32 s56, s56, L_k1_start-L_pc1
    s_addc_u32 s57, s57, 0
    s_lshr_b32 s58, s2, 3
    s_lshl_b32 s58, s58, 13
    v_lshlrev_b32 v60, 4, v0
    v_add_u32 v60, s58, v60
    s_mov_b32 s59, L_k2_end-L_k1_start-16
    v_min_u32 v60, s59, v60
    global_load_dwordx4 v[64:67], v60, s[56:57]
    v_lshrrev_b32 v2, 6, v0
    s_and_b32 s4, s2, 7
    s_lshr_b32 s5, s2, 3
    v_readfirstlane_b32 s6, v2
    v_mov_b32 v159, v0
    v_lshrrev_b32 v2, 3, v0
    v_and_b32 v3, 7, v0
    s_lshl_b32 s54, s5, 6
    v_add_u32 v4, s54, v2
    v_lshlrev_b32 v4, 10, v4
    v_lshl_add_u32 v4, v3, 4, v4
    s_lshl_b32 s55, s4, 7
    v_add_u32 v4, s55, v4
    v_subrev_u32 v5, 3072, v4
    v_add_u32 v6, 62464, v4
    s_mov_b32 s3, 0x20000
    s_mov_b32 s18, 2097152
    s_mov_b32 s19, s3
    s_mov_b32 s22, 2097152
    s_mov_b32 s23, s3
    v_mov_b32 v7, -1
    v_cmp_gt_u32 vcc, 24, v0
    v_and_b32 v0, 63, v0
    s_waitcnt lgkmcnt(0)
    v_cndmask_b32 v6, v7, v6, vcc
    buffer_load_dwordx4 v[8:11], v5, s[16:19], 0 offen
    buffer_load_dwordx4 v[12:15], v4, s[20:23], 0 offen
    buffer_load_dwordx4 v[16:19], v6, s[16:19], 0 offen
    s_load_dwordx2 s[24:25], s[0:1], 24
    s_load_dwordx2 s[8:9], s[0:1], 96
    s_load_dwordx2 s[28:29], s[0:1], 32
    s_load_dwordx2 s[48:49], s[0:1], 88
    s_load_dwordx2 s[52:53], s[0:1], 40
    s_load_dwordx2 s[12:13], s[0:1], 0
    s_load_dwordx2 s[32:33], s[0:1], 56
    s_load_dwordx2 s[36:37], s[0:1], 64
    s_load_dwordx2 s[40:41], s[0:1], 72
    s_load_dwordx2 s[44:45], s[0:1], 80
    s_memrealtime s[58:59]
    s_mov_b32 s26, 4096
    s_mov_b32 s27, s3
    s_mov_b32 s10, 33554432
    s_mov_b32 s11, s3
    s_mov_b32 s30, 2097152
    s_mov_b32 s31, s3
    s_mov_b32 s14, 2097152
    s_mov_b32 s15, s3
    s_mov_b32 s50, 256
    s_mov_b32 s51, s3
    s_mov_b32 s34, 1409024
    s_mov_b32 s35, s3
    s_mov_b32 s38, 1409024
    s_mov_b32 s39, s3
    s_mov_b32 s42, 1409024
    s_mov_b32 s43, s3
    s_mov_b32 s46, 2097152
    s_mov_b32 s47, s3
    v_lshlrev_b32 v1, 4, v0
    s_getreg_b32 s99, hwreg(HW_REG_XCC_ID)
    s_and_b32 s99, s99, 15
    s_mov_b32 s96, 0
    s_mul_i32 s95, s5, 3
    s_min_u32 s95, s95, 83
    v_mul_u32_u24 v20, 132, v2
    v_lshl_add_u32 v20, v3, 4, v20
    v_add_u32 v20, 42496, v20
    s_lshl_b32 s56, s6, 4
    v_lshrrev_b32 v21, 4, v0
    v_lshlrev_b32 v21, 2, v21
    v_add_u32 v21, s56, v21
    v_and_b32 v22, 15, v0
    v_lshlrev_b32 v22, 2, v22
    v_mul_u32_u24 v23, 132, v22
    v_add_u32 v23, v23, v21
    v_add_u32 v23, 42496, v23
    v_add_u32 v21, s55, v21
    v_add_u32 v22, s54, v22
    s_waitcnt lgkmcnt(0)
    v_lshlrev_b32 v24, 2, v21
    buffer_load_dwordx4 v[28:31], v24, s[24:27], 0 offen
    s_cmp_lg_u32 s6, 7
    s_cbranch_scc1 L_z_1
    s_cmp_lg_u32 s5, 0
    s_cbranch_scc1 L_z_1
    s_lshl_b32 s58, s58, 4
    s_or_b32 s58, s58, 15
    v_mov_b32 v25, s58
    s_lshl_b32 s59, s4, 5
    v_mov_b32 v26, s59
    s_mov_b64 exec, 1
    buffer_store_dword v25, v26, s[48:51], 0 offen sc1
    s_mov_b64 exec, -1
L_z_1:
    s_cmp_lg_u32 s6, 6
    s_cbranch_scc1 L_zf_2
    s_cmp_lg_u32 s5, 0
    s_cbranch_scc1 L_zf_2
    v_mov_b32 v25, 0
    v_lshlrev_b32 v26, 2, v0
    s_lshl_b32 s59, s4, 8
    buffer_store_dword v25, v26, s[8:11], s59 offen sc1
L_zf_2:
    s_lshl_b32 s56, s4, 18
    s_lshl_b32 s57, s5, 13
    s_add_u32 s56, s56, s57
    v_lshrrev_b32 v25, 8, v159
    v_and_b32 v26, 255, v159
    v_lshlrev_b32 v27, 12, v25
    v_lshl_add_u32 v27, v26, 4, v27
    buffer_load_dwordx4 v[32:35], v27, s[28:31], s56 offen
    buffer_load_dwordx4 v[36:39], v27, s[28:31], s56 offen offset:16
    v_lshlrev_b32 v40, 12, v0
    v_and_b32 v40, 0x1000, v40
    buffer_load_dwordx4 v[44:47], v40, s[28:31], s56 offen
    v_mul_u32_u24 v25, 16512, v25
    v_lshl_add_u32 v25, v26, 4, v25
    v_add_u32 v25, 32, v25
    s_lshl_b32 s56, s4, 7
    s_lshl_b32 s57, s5, 2
    s_add_u32 s56, s56, s57
    s_load_dword s93, s[52:53], s56
    s_cmp_lg_u32 s6, 0
    s_cbranch_scc1 L_zc_3
    v_mov_b32 v50, 0
    v_mov_b32 v51, 64784
    ds_write_b32 v51, v50 offset:0
    ds_write_b32 v51, v50 offset:16
    ds_write_b32 v51, v50 offset:32
    ds_write_b32 v51, v50 offset:48
    ds_write_b32 v51, v50 offset:52
    ds_write_b32 v51, v50 offset:56
    ds_write_b32 v51, v50 offset:60
    ds_write_b32 v51, v50 offset:64
    ds_write_b32 v51, v50 offset:80
    ds_write_b32 v51, v50 offset:112
    ds_write_b32 v51, v50 offset:128
    ds_write_b32 v51, v50 offset:96
L_zc_3:
    s_lshl_b32 s56, s4, 5
    v_mov_b32 v48, s56
    buffer_load_dword v49, v48, s[48:51], 0 offen sc1
L_k1_start:
    s_waitcnt vmcnt(5)
    ds_write_b32 v20, v8 offset:0
    ds_write_b32 v20, v9 offset:4
    ds_write_b32 v20, v10 offset:8
    ds_write_b32 v20, v11 offset:12
    ds_write_b32 v20, v12 offset:8976
    ds_write_b32 v20, v13 offset:8980
    ds_write_b32 v20, v14 offset:8984
    ds_write_b32 v20, v15 offset:8988
    v_cmp_gt_u32 vcc, 24, v159
    s_and_saveexec_b64 s[56:57], vcc
    s_cbranch_execz L_k2_4
    ds_write_b32 v20, v16 offset:8448
    ds_write_b32 v20, v17 offset:8452
    ds_write_b32 v20, v18 offset:8456
    ds_write_b32 v20, v19 offset:8460
L_k2_4:
    s_mov_b64 exec, s[56:57]
    s_waitcnt lgkmcnt(0)
    s_barrier
    ds_read_b32 v8, v23 offset:0
    ds_read_b32 v9, v23 offset:132
    ds_read_b32 v10, v23 offset:264
    ds_read_b32 v11, v23 offset:396
    ds_read_b32 v12, v23 offset:528
    ds_read_b32 v13, v23 offset:660
    ds_read_b32 v14, v23 offset:792
    ds_read_b32 v16, v23 offset:8976
    ds_read_b32 v17, v23 offset:9108
    ds_read_b32 v18, v23 offset:9240
    ds_read_b32 v19, v23 offset:9372
    s_waitcnt vmcnt(4)
    v_lshlrev_b32 v52, 16, v28
    v_and_b32 v53, 0xffff0000, v28
    v_lshlrev_b32 v54, 16, v29
    v_and_b32 v55, 0xffff0000, v29
    v_lshlrev_b32 v56, 16, v30
    v_and_b32 v57, 0xffff0000, v30
    v_lshlrev_b32 v58, 16, v31
    v_and_b32 v59, 0xffff0000, v31
    s_waitcnt lgkmcnt(4)
    v_lshlrev_b32 v60, 16, v8
    v_and_b32 v68, 0xffff0000, v8
    v_lshlrev_b32 v61, 16, v9
    v_and_b32 v69, 0xffff0000, v9
    v_lshlrev_b32 v62, 16, v10
    v_and_b32 v70, 0xffff0000, v10
    v_lshlrev_b32 v63, 16, v11
    v_and_b32 v71, 0xffff0000, v11
    v_lshlrev_b32 v64, 16, v12
    v_and_b32 v72, 0xffff0000, v12
    v_lshlrev_b32 v65, 16, v13
    v_and_b32 v73, 0xffff0000, v13
    v_lshlrev_b32 v66, 16, v14
    v_and_b32 v74, 0xffff0000, v14
    v_mul_f32 v76, v60, v55
    v_mul_f32 v77, v61, v55
    v_mul_f32 v78, v62, v55
    v_mul_f32 v79, v63, v55
    v_mul_f32 v80, v68, v59
    v_mul_f32 v81, v69, v59
    v_mul_f32 v82, v70, v59
    v_mul_f32 v83, v71, v59
    v_fmac_f32 v76, v61, v54
    v_fmac_f32 v77, v62, v54
    v_fmac_f32 v78, v63, v54
    v_fmac_f32 v79, v64, v54
    v_fmac_f32 v80, v69, v58
    v_fmac_f32 v81, v70, v58
    v_fmac_f32 v82, v71, v58
    v_fmac_f32 v83, v72, v58
    v_fmac_f32 v76, v62, v53
    v_fmac_f32 v77, v63, v53
    v_fmac_f32 v78, v64, v53
    v_fmac_f32 v79, v65, v53
    v_fmac_f32 v80, v70, v57
    v_fmac_f32 v81, v71, v57
    v_fmac_f32 v82, v72, v57
    v_fmac_f32 v83, v73, v57
    v_fmac_f32 v76, v63, v52
    v_fmac_f32 v77, v64, v52
    v_fmac_f32 v78, v65, v52
    v_fmac_f32 v79, v66, v52
    v_fmac_f32 v80, v71, v56
    v_fmac_f32 v81, v72, v56
    v_fmac_f32 v82, v73, v56
    v_fmac_f32 v83, v74, v56
    s_waitcnt lgkmcnt(0)
    v_lshlrev_b32 v84, 16, v16
    v_and_b32 v85, 0xffff0000, v16
    v_lshlrev_b32 v86, 16, v17
    v_and_b32 v87, 0xffff0000, v17
    v_lshlrev_b32 v88, 16, v18
    v_and_b32 v89, 0xffff0000, v18
    v_lshlrev_b32 v90, 16, v19
    v_and_b32 v91, 0xffff0000, v19
    v_mul_f32 v76, v76, v84
    v_mul_f32 v80, v80, v85
    v_mul_f32 v77, v77, v86
    v_mul_f32 v81, v81, v87
    v_mul_f32 v78, v78, v88
    v_mul_f32 v82, v82, v89
    v_mul_f32 v79, v79, v90
    v_mul_f32 v83, v83, v91
    v_lshlrev_b32 v96, 11, v21
    v_sub_u32 v97, 2044, v22
    v_lshl_add_u32 v96, v97, 1, v96
    v_add_u32 v96, 1048576, v96
    v_add_u32 v97, 4096, v96
    v_cvt_pk_bf16_f32 v92, v79, v78
    v_cvt_pk_bf16_f32 v93, v77, v76
    v_cvt_pk_bf16_f32 v94, v83, v82
    v_cvt_pk_bf16_f32 v95, v81, v80
    buffer_store_dwordx2 v[92:93], v96, s[8:11], 0 offen sc1
    buffer_store_dwordx2 v[94:95], v97, s[8:11], 0 offen sc1
    s_waitcnt vmcnt(2)
    v_alignbit_b32 v100, v33, v32, 16
    v_alignbit_b32 v104, v34, v33, 16
    v_mov_b32 v108, v33
    v_alignbit_b32 v101, v34, v33, 16
    v_alignbit_b32 v105, v35, v34, 16
    v_mov_b32 v109, v34
    v_alignbit_b32 v102, v35, v34, 16
    v_alignbit_b32 v106, v36, v35, 16
    v_mov_b32 v110, v35
    v_alignbit_b32 v103, v36, v35, 16
    v_alignbit_b32 v107, v37, v36, 16
    v_mov_b32 v111, v36
    ds_write_b128 v25, v[32:35] offset:0
    ds_write_b128 v25, v[100:103] offset:4128
    ds_write_b128 v25, v[108:111] offset:8256
    ds_write_b128 v25, v[104:107] offset:12384
    s_cmp_lg_u32 s6, 7
    s_cbranch_scc1 L_pad_5
    v_mov_b32 v40, 0
    v_mov_b32 v41, 0
    v_mov_b32 v42, 0
    v_mov_b32 v43, 0
    v_and_b32 v26, 1, v0
    v_mul_u32_u24 v26, 16512, v26
    v_add_u32 v26, 16, v26
    s_mov_b64 exec, 3
    v_alignbit_b32 v100, v41, v40, 16
    v_alignbit_b32 v104, v42, v41, 16
    v_mov_b32 v108, v41
    v_alignbit_b32 v101, v42, v41, 16
    v_alignbit_b32 v105, v43, v42, 16
    v_mov_b32 v109, v42
    v_alignbit_b32 v102, v43, v42, 16
    v_alignbit_b32 v106, v44, v43, 16
    v_mov_b32 v110, v43
    v_alignbit_b32 v103, v44, v43, 16
    v_alignbit_b32 v107, v45, v44, 16
    v_mov_b32 v111, v44
    ds_write_b128 v26, v[40:43] offset:0
    ds_write_b128 v26, v[100:103] offset:4128
    ds_write_b128 v26, v[108:111] offset:8256
    ds_write_b128 v26, v[104:107] offset:12384
    v_mov_b32 v44, 0
    v_mov_b32 v45, 0
    v_mov_b32 v46, 0
    v_mov_b32 v47, 0
    v_subrev_u32 v26, 16, v26
    ds_write_b128 v26, v[44:47] offset:0
    ds_write_b128 v26, v[44:47] offset:4128
    ds_write_b128 v26, v[44:47] offset:8256
    ds_write_b128 v26, v[44:47] offset:12384
    s_mov_b64 exec, -1
L_pad_5:
    s_cmp_lg_u32 s6, 6
    s_cbranch_scc1 L_xz_6
    v_lshrrev_b32 v26, 5, v0
    v_mul_u32_u24 v26, 4608, v26
    v_and_b32 v27, 31, v0
    v_lshl_add_u32 v26, v27, 4, v26
    v_add_u32 v26, 37376, v26
    v_mov_b32 v40, 0
    v_mov_b32 v41, 0
    v_mov_b32 v42, 0
    v_mov_b32 v43, 0
    ds_write_b128 v26, v[40:43]
L_xz_6:
    s_waitcnt vmcnt(0)
    s_cmp_lg_u32 s6, 0
    s_cbranch_scc1 L_n_7
    v_readfirstlane_b32 s97, v49
    s_cmp_lg_u32 s97, 0
    s_cbranch_scc1 L_n_7_ok
    s_mov_b32 s98, 0
L_poll_8:
    buffer_load_dword v152, v48, s[48:51], 0 offen sc1
    s_waitcnt vmcnt(0)
    v_cmp_ne_u32 vcc, 0, v152
    s_add_u32 s98, s98, 1
    s_cmp_eq_u64 vcc, -1
    s_cbranch_scc1 L_poll_8_d
    s_cmp_lt_u32 s98, 0x8000
    s_cbranch_scc1 L_poll_8
L_poll_8_d:
    v_readfirstlane_b32 s97, v152
L_n_7_ok:
    s_and_b32 s97, s97, 0xfffffff0
    s_or_b32 s97, s97, 1
L_n_7:
    s_waitcnt lgkmcnt(0)
    s_barrier
    s_mov_b32 s90, 0
    s_cmp_ge_u32 s6, 4
    s_cbranch_scc1 L_helper
    s_cmp_lg_u32 s6, 0
    s_cbranch_scc1 L_s1_9
    v_mov_b32 v156, s97
    v_mov_b32 v157, s99
    s_lshl_b32 s98, s4, 5
    s_add_u32 s98, s98, s5
    s_lshl_b32 s98, s98, 7
    s_add_u32 s98, s98, 65536
    v_mov_b32 v158, s98
    s_mov_b64 exec, 1
    buffer_store_dwordx2 v[156:157], v158, s[8:11], 0 offen sc1
    s_mov_b64 exec, -1
L_s1_9:
    v_and_b32 v2, 15, v0
    v_add_u32 v2, 1, v2
    v_and_b32 v3, 3, v2
    v_sub_u32 v2, v2, v3
    v_mul_u32_u24 v3, 4128, v3
    v_lshrrev_b32 v4, 4, v0
    v_lshlrev_b32 v2, 1, v2
    v_add_u32 v3, v3, v2
    v_lshlrev_b32 v2, 4, v4
    v_sub_u32 v3, v3, v2
    s_lshr_b32 s54, s6, 1
    s_mul_i32 s56, s54, 16512
    s_and_b32 s55, s6, 1
    s_lshl_b32 s55, s55, 6
    s_add_u32 s56, s56, s55
    s_add_u32 s56, s56, 48
    v_add_u32 v3, s56, v3
    s_mul_i32 s54, s54, 4608
    s_add_u32 s54, s54, s55
    s_add_u32 s54, s54, 33808
    v_and_b32 v5, 15, v0
    v_lshlrev_b32 v5, 5, v5
    v_lshl_add_u32 v5, v4, 4, v5
    v_sub_u32 v5, s54, v5
    v_lshlrev_b32 v7, 4, v159
    v_add_u32 v6, 33280, v7
    s_lshl_b32 s54, s4, 18
    s_lshl_b32 s55, s5, 13
    s_add_u32 s54, s54, s55
    s_add_u32 s59, s54, 1048576
    v_mov_b32 v10, 64784
    s_cmp_lg_u32 s6, 0
    s_cbranch_scc1 L_s1_9_e
    v_and_b32 v158, 31, v0
    v_lshlrev_b32 v158, 7, v158
    s_lshl_b32 s54, s4, 12
    s_add_u32 s54, s54, 65536
    v_add_u32 v158, s54, v158
    s_mov_b32 s98, 0
L_poll_10:
    buffer_load_dwordx2 v[152:153], v158, s[8:11], 0 offen sc1
    s_waitcnt vmcnt(0)
    v_subrev_u32 v154, s97, v152
    v_cmp_gt_u32 vcc, 16, v154
    s_add_u32 s98, s98, 1
    s_cmp_eq_u64 vcc, -1
    s_cbranch_scc1 L_poll_10_d
    s_cmp_lt_u32 s98, 0x8000
    s_cbranch_scc1 L_poll_10
L_poll_10_d:
    v_cmp_eq_u32 vcc, s99, v153
    s_cmp_eq_u64 vcc, -1
    s_cselect_b32 s96, 1, 0
    v_mov_b32 v152, s96
    v_mov_b32 v153, s97
    v_mov_b32 v154, 64768
    ds_write_b64 v154, v[152:153]
L_s1_9_e:
    v_mov_b32 v11, 1
    s_add_u32 s90, s90, 4
    s_waitcnt lgkmcnt(0)
    s_mov_b64 exec, 1
    ds_add_u32 v10, v11
    s_mov_b64 exec, -1
    s_mov_b32 s98, 0
L_s4_11:
    ds_read_b32 v11, v10
    s_waitcnt lgkmcnt(0)
    v_readfirstlane_b32 s63, v11
    s_add_u32 s98, s98, 1
    s_cmp_ge_u32 s63, s90
    s_cbranch_scc1 L_s4_11_d
    s_cmp_lt_u32 s98, 0x100000
    s_cbranch_scc1 L_s4_11
L_s4_11_d:
    buffer_load_dwordx4 v[12:15], v7, s[8:11], s59 offen sc1
    s_add_u32 s59, s59, 4096
    buffer_load_dwordx4 v[16:19], v7, s[8:11], s59 offen sc1
    ds_read_b64 v[192:193], v3 offset:0
    ds_read_b64 v[194:195], v3 offset:8
    ds_read_b64 v[196:197], v3 offset:128
    ds_read_b64 v[198:199], v3 offset:136
    s_waitcnt vmcnt(1)
    ds_write_b128 v6, v[12:15]
    s_waitcnt vmcnt(0)
    ds_write_b128 v6, v[16:19] offset:4608
    v_mov_b32 v11, 1
    s_add_u32 s90, s90, 4
    s_waitcnt lgkmcnt(0)
    s_mov_b64 exec, 1
    ds_add_u32 v10, v11
    s_mov_b64 exec, -1
    s_mov_b32 s98, 0
L_s4_12:
    ds_read_b32 v11, v10
    s_waitcnt lgkmcnt(0)
    v_readfirstlane_b32 s63, v11
    s_add_u32 s98, s98, 1
    s_cmp_ge_u32 s63, s90
    s_cbranch_scc1 L_s4_12_d
    s_cmp_lt_u32 s98, 0x100000
    s_cbranch_scc1 L_s4_12
L_s4_12_d:
    ds_read_b128 v[16:19], v5 offset:3968
    ds_read_b128 v[20:23], v5 offset:3840
    ds_read_b128 v[24:27], v5 offset:3712
    ds_read_b128 v[28:31], v5 offset:3584
    ds_read_b128 v[32:35], v5 offset:3456
    ds_read_b128 v[36:39], v5 offset:3328
    ds_read_b128 v[40:43], v5 offset:3200
    ds_read_b128 v[44:47], v5 offset:3072
    ds_read_b128 v[48:51], v5 offset:2944
    ds_read_b128 v[52:55], v5 offset:2816
    ds_read_b128 v[56:59], v5 offset:2688
    ds_read_b128 v[60:63], v5 offset:2560
    ds_read_b128 v[64:67], v5 offset:2432
    ds_read_b128 v[68:71], v5 offset:2304
    ds_read_b128 v[72:75], v5 offset:2176
    ds_read_b128 v[76:79], v5 offset:2048
    ds_read_b128 v[80:83], v5 offset:1920
    ds_read_b128 v[84:87], v5 offset:1792
    ds_read_b128 v[88:91], v5 offset:1664
    ds_read_b128 v[92:95], v5 offset:1536
    ds_read_b128 v[96:99], v5 offset:1408
    ds_read_b128 v[100:103], v5 offset:1280
    ds_read_b128 v[104:107], v5 offset:1152
    ds_read_b128 v[108:111], v5 offset:1024
    ds_read_b128 v[112:115], v5 offset:896
    ds_read_b128 v[116:119], v5 offset:768
    ds_read_b128 v[120:123], v5 offset:640
    ds_read_b128 v[124:127], v5 offset:512
    ds_read_b128 v[128:131], v5 offset:384
    ds_read_b128 v[132:135], v5 offset:256
    ds_read_b128 v[136:139], v5 offset:128
    ds_read_b128 v[140:143], v5 offset:0
    s_waitcnt lgkmcnt(0)
    s_setprio 2
    ds_read_b64 v[200:201], v3 offset:256
    ds_read_b64 v[202:203], v3 offset:264
    v_mfma_f32_16x16x32_bf16 v[208:211], v[192:195], v[28:31], 0
    v_mfma_f32_16x16x32_bf16 v[212:215], v[192:195], v[44:47], 0
    v_mfma_f32_16x16x32_bf16 v[216:219], v[192:195], v[60:63], 0
    v_mfma_f32_16x16x32_bf16 v[220:223], v[192:195], v[76:79], 0
    v_mfma_f32_16x16x32_bf16 v[224:227], v[192:195], v[92:95], 0
    v_mfma_f32_16x16x32_bf16 v[228:231], v[192:195], v[108:111], 0
    v_mfma_f32_16x16x32_bf16 v[232:235], v[192:195], v[124:127], 0
    v_mfma_f32_16x16x32_bf16 v[236:239], v[192:195], v[140:143], 0
    ds_read_b64 v[204:205], v3 offset:384
    ds_read_b64 v[206:207], v3 offset:392
    s_waitcnt lgkmcnt(4)
    v_mfma_f32_16x16x32_bf16 v[208:211], v[196:199], v[24:27], v[208:211]
    v_mfma_f32_16x16x32_bf16 v[212:215], v[196:199], v[40:43], v[212:215]
    v_mfma_f32_16x16x32_bf16 v[216:219], v[196:199], v[56:59], v[216:219]
    v_mfma_f32_16x16x32_bf16 v[220:223], v[196:199], v[72:75], v[220:223]
    v_mfma_f32_16x16x32_bf16 v[224:227], v[196:199], v[88:91], v[224:227]
    v_mfma_f32_16x16x32_bf16 v[228:231], v[196:199], v[104:107], v[228:231]
    v_mfma_f32_16x16x32_bf16 v[232:235], v[196:199], v[120:123], v[232:235]
    v_mfma_f32_16x16x32_bf16 v[236:239], v[196:199], v[136:139], v[236:239]
    ds_read_b64 v[192:193], v3 offset:512
    ds_read_b64 v[194:195], v3 offset:520
    s_waitcnt lgkmcnt(4)
    v_mfma_f32_16x16x32_bf16 v[208:211], v[200:203], v[20:23], v[208:211]
    v_mfma_f32_16x16x32_bf16 v[212:215], v[200:203], v[36:39], v[212:215]
    v_mfma_f32_16x16x32_bf16 v[216:219], v[200:203], v[52:55], v[216:219]
    v_mfma_f32_16x16x32_bf16 v[220:223], v[200:203], v[68:71], v[220:223]
    v_mfma_f32_16x16x32_bf16 v[224:227], v[200:203], v[84:87], v[224:227]
    v_mfma_f32_16x16x32_bf16 v[228:231], v[200:203], v[100:103], v[228:231]
    v_mfma_f32_16x16x32_bf16 v[232:235], v[200:203], v[116:119], v[232:235]
    v_mfma_f32_16x16x32_bf16 v[236:239], v[200:203], v[132:135], v[236:239]
    ds_read_b64 v[196:197], v3 offset:640
    ds_read_b64 v[198:199], v3 offset:648
    s_waitcnt lgkmcnt(4)
    v_mfma_f32_16x16x32_bf16 v[208:211], v[204:207], v[16:19], v[208:211]
    v_mfma_f32_16x16x32_bf16 v[212:215], v[204:207], v[32:35], v[212:215]
    v_mfma_f32_16x16x32_bf16 v[216:219], v[204:207], v[48:51], v[216:219]
    v_mfma_f32_16x16x32_bf16 v[220:223], v[204:207], v[64:67], v[220:223]
    v_mfma_f32_16x16x32_bf16 v[224:227], v[204:207], v[80:83], v[224:227]
    v_mfma_f32_16x16x32_bf16 v[228:231], v[204:207], v[96:99], v[228:231]
    v_mfma_f32_16x16x32_bf16 v[232:235], v[204:207], v[112:115], v[232:235]
    v_mfma_f32_16x16x32_bf16 v[236:239], v[204:207], v[128:131], v[236:239]
    ds_read_b64 v[200:201], v3 offset:768
    ds_read_b64 v[202:203], v3 offset:776
    s_waitcnt lgkmcnt(4)
    v_mfma_f32_16x16x32_bf16 v[212:215], v[192:195], v[28:31], v[212:215]
    v_mfma_f32_16x16x32_bf16 v[216:219], v[192:195], v[44:47], v[216:219]
    v_mfma_f32_16x16x32_bf16 v[220:223], v[192:195], v[60:63], v[220:223]
    v_mfma_f32_16x16x32_bf16 v[224:227], v[192:195], v[76:79], v[224:227]
    v_mfma_f32_16x16x32_bf16 v[228:231], v[192:195], v[92:95], v[228:231]
    v_mfma_f32_16x16x32_bf16 v[232:235], v[192:195], v[108:111], v[232:235]
    v_mfma_f32_16x16x32_bf16 v[236:239], v[192:195], v[124:127], v[236:239]
    ds_read_b64 v[204:205], v3 offset:896
    ds_read_b64 v[206:207], v3 offset:904
    s_waitcnt lgkmcnt(4)
    v_mfma_f32_16x16x32_bf16 v[212:215], v[196:199], v[24:27], v[212:215]
    v_mfma_f32_16x16x32_bf16 v[216:219], v[196:199], v[40:43], v[216:219]
    v_mfma_f32_16x16x32_bf16 v[220:223], v[196:199], v[56:59], v[220:223]
    v_mfma_f32_16x16x32_bf16 v[224:227], v[196:199], v[72:75], v[224:227]
    v_mfma_f32_16x16x32_bf16 v[228:231], v[196:199], v[88:91], v[228:231]
    v_mfma_f32_16x16x32_bf16 v[232:235], v[196:199], v[104:107], v[232:235]
    v_mfma_f32_16x16x32_bf16 v[236:239], v[196:199], v[120:123], v[236:239]
    ds_read_b64 v[192:193], v3 offset:1024
    ds_read_b64 v[194:195], v3 offset:1032
    s_waitcnt lgkmcnt(4)
    v_mfma_f32_16x16x32_bf16 v[212:215], v[200:203], v[20:23], v[212:215]
    v_mfma_f32_16x16x32_bf16 v[216:219], v[200:203], v[36:39], v[216:219]
    v_mfma_f32_16x16x32_bf16 v[220:223], v[200:203], v[52:55], v[220:223]
    v_mfma_f32_16x16x32_bf16 v[224:227], v[200:203], v[68:71], v[224:227]
    v_mfma_f32_16x16x32_bf16 v[228:231], v[200:203], v[84:87], v[228:231]
    v_mfma_f32_16x16x32_bf16 v[232:235], v[200:203], v[100:103], v[232:235]
    v_mfma_f32_16x16x32_bf16 v[236:239], v[200:203], v[116:119], v[236:239]
    ds_read_b64 v[196:197], v3 offset:1152
    ds_read_b64 v[198:199], v3 offset:1160
    s_waitcnt lgkmcnt(4)
    v_mfma_f32_16x16x32_bf16 v[212:215], v[204:207], v[16:19], v[212:215]
    v_mfma_f32_16x16x32_bf16 v[216:219], v[204:207], v[32:35], v[216:219]
    v_mfma_f32_16x16x32_bf16 v[220:223], v[204:207], v[48:51], v[220:223]
    v_mfma_f32_16x16x32_bf16 v[224:227], v[204:207], v[64:67], v[224:227]
    v_mfma_f32_16x16x32_bf16 v[228:231], v[204:207], v[80:83], v[228:231]
    v_mfma_f32_16x16x32_bf16 v[232:235], v[204:207], v[96:99], v[232:235]
    v_mfma_f32_16x16x32_bf16 v[236:239], v[204:207], v[112:115], v[236:239]
    ds_read_b64 v[200:201], v3 offset:1280
    ds_read_b64 v[202:203], v3 offset:1288
    s_waitcnt lgkmcnt(4)
    v_mfma_f32_16x16x32_bf16 v[216:219], v[192:195], v[28:31], v[216:219]
    v_mfma_f32_16x16x32_bf16 v[220:223], v[192:195], v[44:47], v[220:223]
    v_mfma_f32_16x16x32_bf16 v[224:227], v[192:195], v[60:63], v[224:227]
    v_mfma_f32_16x16x32_bf16 v[228:231], v[192:195], v[76:79], v[228:231]
    v_mfma_f32_16x16x32_bf16 v[232:235], v[192:195], v[92:95], v[232:235]
    v_mfma_f32_16x16x32_bf16 v[236:239], v[192:195], v[108:111], v[236:239]
    ds_read_b64 v[204:205], v3 offset:1408
    ds_read_b64 v[206:207], v3 offset:1416
    s_waitcnt lgkmcnt(4)
    v_mfma_f32_16x16x32_bf16 v[216:219], v[196:199], v[24:27], v[216:219]
    v_mfma_f32_16x16x32_bf16 v[220:223], v[196:199], v[40:43], v[220:223]
    v_mfma_f32_16x16x32_bf16 v[224:227], v[196:199], v[56:59], v[224:227]
    v_mfma_f32_16x16x32_bf16 v[228:231], v[196:199], v[72:75], v[228:231]
    v_mfma_f32_16x16x32_bf16 v[232:235], v[196:199], v[88:91], v[232:235]
    v_mfma_f32_16x16x32_bf16 v[236:239], v[196:199], v[104:107], v[236:239]
    ds_read_b64 v[192:193], v3 offset:1536
    ds_read_b64 v[194:195], v3 offset:1544
    s_waitcnt lgkmcnt(4)
    v_mfma_f32_16x16x32_bf16 v[216:219], v[200:203], v[20:23], v[216:219]
    v_mfma_f32_16x16x32_bf16 v[220:223], v[200:203], v[36:39], v[220:223]
    v_mfma_f32_16x16x32_bf16 v[224:227], v[200:203], v[52:55], v[224:227]
    v_mfma_f32_16x16x32_bf16 v[228:231], v[200:203], v[68:71], v[228:231]
    v_mfma_f32_16x16x32_bf16 v[232:235], v[200:203], v[84:87], v[232:235]
    v_mfma_f32_16x16x32_bf16 v[236:239], v[200:203], v[100:103], v[236:239]
    ds_read_b64 v[196:197], v3 offset:1664
    ds_read_b64 v[198:199], v3 offset:1672
    s_waitcnt lgkmcnt(4)
    v_mfma_f32_16x16x32_bf16 v[216:219], v[204:207], v[16:19], v[216:219]
    v_mfma_f32_16x16x32_bf16 v[220:223], v[204:207], v[32:35], v[220:223]
    v_mfma_f32_16x16x32_bf16 v[224:227], v[204:207], v[48:51], v[224:227]
    v_mfma_f32_16x16x32_bf16 v[228:231], v[204:207], v[64:67], v[228:231]
    v_mfma_f32_16x16x32_bf16 v[232:235], v[204:207], v[80:83], v[232:235]
    v_mfma_f32_16x16x32_bf16 v[236:239], v[204:207], v[96:99], v[236:239]
    ds_read_b64 v[200:201], v3 offset:1792
    ds_read_b64 v[202:203], v3 offset:1800
    s_waitcnt lgkmcnt(4)
    v_mfma_f32_16x16x32_bf16 v[220:223], v[192:195], v[28:31], v[220:223]
    v_mfma_f32_16x16x32_bf16 v[224:227], v[192:195], v[44:47], v[224:227]
    v_mfma_f32_16x16x32_bf16 v[228:231], v[192:195], v[60:63], v[228:231]
    v_mfma_f32_16x16x32_bf16 v[232:235], v[192:195], v[76:79], v[232:235]
    v_mfma_f32_16x16x32_bf16 v[236:239], v[192:195], v[92:95], v[236:239]
    ds_read_b64 v[204:205], v3 offset:1920
    ds_read_b64 v[206:207], v3 offset:1928
    s_waitcnt lgkmcnt(4)
    v_mfma_f32_16x16x32_bf16 v[220:223], v[196:199], v[24:27], v[220:223]
    v_mfma_f32_16x16x32_bf16 v[224:227], v[196:199], v[40:43], v[224:227]
    v_mfma_f32_16x16x32_bf16 v[228:231], v[196:199], v[56:59], v[228:231]
    v_mfma_f32_16x16x32_bf16 v[232:235], v[196:199], v[72:75], v[232:235]
    v_mfma_f32_16x16x32_bf16 v[236:239], v[196:199], v[88:91], v[236:239]
    ds_read_b64 v[192:193], v3 offset:2048
    ds_read_b64 v[194:195], v3 offset:2056
    s_waitcnt lgkmcnt(4)
    v_mfma_f32_16x16x32_bf16 v[220:223], v[200:203], v[20:23], v[220:223]
    v_mfma_f32_16x16x32_bf16 v[224:227], v[200:203], v[36:39], v[224:227]
    v_mfma_f32_16x16x32_bf16 v[228:231], v[200:203], v[52:55], v[228:231]
    v_mfma_f32_16x16x32_bf16 v[232:235], v[200:203], v[68:71], v[232:235]
    v_mfma_f32_16x16x32_bf16 v[236:239], v[200:203], v[84:87], v[236:239]
    ds_read_b64 v[196:197], v3 offset:2176
    ds_read_b64 v[198:199], v3 offset:2184
    s_waitcnt lgkmcnt(4)
    v_mfma_f32_16x16x32_bf16 v[220:223], v[204:207], v[16:19], v[220:223]
    v_mfma_f32_16x16x32_bf16 v[224:227], v[204:207], v[32:35], v[224:227]
    v_mfma_f32_16x16x32_bf16 v[228:231], v[204:207], v[48:51], v[228:231]
    v_mfma_f32_16x16x32_bf16 v[232:235], v[204:207], v[64:67], v[232:235]
    v_mfma_f32_16x16x32_bf16 v[236:239], v[204:207], v[80:83], v[236:239]
    ds_read_b64 v[200:201], v3 offset:2304
    ds_read_b64 v[202:203], v3 offset:2312
    s_waitcnt lgkmcnt(4)
    v_mfma_f32_16x16x32_bf16 v[224:227], v[192:195], v[28:31], v[224:227]
    v_mfma_f32_16x16x32_bf16 v[228:231], v[192:195], v[44:47], v[228:231]
    v_mfma_f32_16x16x32_bf16 v[232:235], v[192:195], v[60:63], v[232:235]
    v_mfma_f32_16x16x32_bf16 v[236:239], v[192:195], v[76:79], v[236:239]
    ds_read_b64 v[204:205], v3 offset:2432
    ds_read_b64 v[206:207], v3 offset:2440
    s_waitcnt lgkmcnt(4)
    v_mfma_f32_16x16x32_bf16 v[224:227], v[196:199], v[24:27], v[224:227]
    v_mfma_f32_16x16x32_bf16 v[228:231], v[196:199], v[40:43], v[228:231]
    v_mfma_f32_16x16x32_bf16 v[232:235], v[196:199], v[56:59], v[232:235]
    v_mfma_f32_16x16x32_bf16 v[236:239], v[196:199], v[72:75], v[236:239]
    ds_read_b64 v[192:193], v3 offset:2560
    ds_read_b64 v[194:195], v3 offset:2568
    s_waitcnt lgkmcnt(4)
    v_mfma_f32_16x16x32_bf16 v[224:227], v[200:203], v[20:23], v[224:227]
    v_mfma_f32_16x16x32_bf16 v[228:231], v[200:203], v[36:39], v[228:231]
    v_mfma_f32_16x16x32_bf16 v[232:235], v[200:203], v[52:55], v[232:235]
    v_mfma_f32_16x16x32_bf16 v[236:239], v[200:203], v[68:71], v[236:239]
    ds_read_b64 v[196:197], v3 offset:2688
    ds_read_b64 v[198:199], v3 offset:2696
    s_waitcnt lgkmcnt(4)
    v_mfma_f32_16x16x32_bf16 v[224:227], v[204:207], v[16:19], v[224:227]
    v_mfma_f32_16x16x32_bf16 v[228:231], v[204:207], v[32:35], v[228:231]
    v_mfma_f32_16x16x32_bf16 v[232:235], v[204:207], v[48:51], v[232:235]
    v_mfma_f32_16x16x32_bf16 v[236:239], v[204:207], v[64:67], v[236:239]
    ds_read_b64 v[200:201], v3 offset:2816
    ds_read_b64 v[202:203], v3 offset:2824
    s_waitcnt lgkmcnt(4)
    v_mfma_f32_16x16x32_bf16 v[228:231], v[192:195], v[28:31], v[228:231]
    v_mfma_f32_16x16x32_bf16 v[232:235], v[192:195], v[44:47], v[232:235]
    v_mfma_f32_16x16x32_bf16 v[236:239], v[192:195], v[60:63], v[236:239]
    ds_read_b64 v[204:205], v3 offset:2944
    ds_read_b64 v[206:207], v3 offset:2952
    s_waitcnt lgkmcnt(4)
    v_mfma_f32_16x16x32_bf16 v[228:231], v[196:199], v[24:27], v[228:231]
    v_mfma_f32_16x16x32_bf16 v[232:235], v[196:199], v[40:43], v[232:235]
    v_mfma_f32_16x16x32_bf16 v[236:239], v[196:199], v[56:59], v[236:239]
    ds_read_b64 v[192:193], v3 offset:3072
    ds_read_b64 v[194:195], v3 offset:3080
    s_waitcnt lgkmcnt(4)
    v_mfma_f32_16x16x32_bf16 v[228:231], v[200:203], v[20:23], v[228:231]
    v_mfma_f32_16x16x32_bf16 v[232:235], v[200:203], v[36:39], v[232:235]
    v_mfma_f32_16x16x32_bf16 v[236:239], v[200:203], v[52:55], v[236:239]
    ds_read_b64 v[196:197], v3 offset:3200
    ds_read_b64 v[198:199], v3 offset:3208
    s_waitcnt lgkmcnt(4)
    v_mfma_f32_16x16x32_bf16 v[228:231], v[204:207], v[16:19], v[228:231]
    v_mfma_f32_16x16x32_bf16 v[232:235], v[204:207], v[32:35], v[232:235]
    v_mfma_f32_16x16x32_bf16 v[236:239], v[204:207], v[48:51], v[236:239]
    ds_read_b64 v[200:201], v3 offset:3328
    ds_read_b64 v[202:203], v3 offset:3336
    s_waitcnt lgkmcnt(4)
    v_mfma_f32_16x16x32_bf16 v[232:235], v[192:195], v[28:31], v[232:235]
    v_mfma_f32_16x16x32_bf16 v[236:239], v[192:195], v[44:47], v[236:239]
    ds_read_b64 v[204:205], v3 offset:3456
    ds_read_b64 v[206:207], v3 offset:3464
    s_waitcnt lgkmcnt(4)
    v_mfma_f32_16x16x32_bf16 v[232:235], v[196:199], v[24:27], v[232:235]
    v_mfma_f32_16x16x32_bf16 v[236:239], v[196:199], v[40:43], v[236:239]
    ds_read_b64 v[192:193], v3 offset:3584
    ds_read_b64 v[194:195], v3 offset:3592
    s_waitcnt lgkmcnt(4)
    v_mfma_f32_16x16x32_bf16 v[232:235], v[200:203], v[20:23], v[232:235]
    v_mfma_f32_16x16x32_bf16 v[236:239], v[200:203], v[36:39], v[236:239]
    ds_read_b64 v[196:197], v3 offset:3712
    ds_read_b64 v[198:199], v3 offset:3720
    s_waitcnt lgkmcnt(4)
    v_mfma_f32_16x16x32_bf16 v[232:235], v[204:207], v[16:19], v[232:235]
    v_mfma_f32_16x16x32_bf16 v[236:239], v[204:207], v[32:35], v[236:239]
    ds_read_b64 v[200:201], v3 offset:3840
    ds_read_b64 v[202:203], v3 offset:3848
    s_waitcnt lgkmcnt(4)
    v_mfma_f32_16x16x32_bf16 v[236:239], v[192:195], v[28:31], v[236:239]
    ds_read_b64 v[204:205], v3 offset:3968
    ds_read_b64 v[206:207], v3 offset:3976
    s_waitcnt lgkmcnt(4)
    v_mfma_f32_16x16x32_bf16 v[236:239], v[196:199], v[24:27], v[236:239]
    s_waitcnt lgkmcnt(2)
    v_mfma_f32_16x16x32_bf16 v[236:239], v[200:203], v[20:23], v[236:239]
    s_waitcnt lgkmcnt(0)
    v_mfma_f32_16x16x32_bf16 v[236:239], v[204:207], v[16:19], v[236:239]
    s_setprio 0
    v_and_b32 v8, 15, v0
    v_lshlrev_b32 v8, 4, v8
    v_lshrrev_b32 v9, 4, v0
    v_lshl_add_u32 v8, v9, 2, v8
    s_lshl_b32 s54, s6, 9
    v_add_u32 v8, s54, v8
    v_sub_u32 v9, 2044, v8
    v_lshlrev_b32 v9, 1, v9
    v_add_u32 v9, 32768, v9
    ds_read_b64 v[16:17], v9 offset:512
    ds_read_b64 v[18:19], v9 offset:5120
    ds_read_b64 v[20:21], v9 offset:0
    ds_read_b64 v[22:23], v9 offset:4608
    s_lshl_b32 s54, s6, 13
    v_add_u32 v7, s54, v1
    v_mov_b32 v11, 1
    s_add_u32 s90, s90, 4
    s_waitcnt lgkmcnt(0)
    s_mov_b64 exec, 1
    ds_add_u32 v10, v11
    s_mov_b64 exec, -1
    s_mov_b32 s98, 0
L_s4_13:
    ds_read_b32 v11, v10
    s_waitcnt lgkmcnt(0)
    v_readfirstlane_b32 s63, v11
    s_add_u32 s98, s98, 1
    s_cmp_ge_u32 s63, s90
    s_cbranch_scc1 L_s4_13_d
    s_cmp_lt_u32 s98, 0x100000
    s_cbranch_scc1 L_s4_13
L_s4_13_d:
    ds_write_b128 v7, v[208:211] offset:0
    ds_write_b128 v7, v[212:215] offset:1024
    ds_write_b128 v7, v[216:219] offset:2048
    ds_write_b128 v7, v[220:223] offset:3072
    ds_write_b128 v7, v[224:227] offset:4096
    ds_write_b128 v7, v[228:231] offset:5120
    ds_write_b128 v7, v[232:235] offset:6144
    ds_write_b128 v7, v[236:239] offset:7168
    s_lshl_b32 s54, s6, 11
    v_add_u32 v7, s54, v1
    s_and_b32 s94, s93, 0xffff0000
    s_lshl_b32 s93, s93, 16
    v_mov_b32 v11, 1
    s_add_u32 s90, s90, 4
    s_waitcnt lgkmcnt(0)
    s_mov_b64 exec, 1
    ds_add_u32 v10, v11
    s_mov_b64 exec, -1
    s_mov_b32 s98, 0
L_s4_14:
    ds_read_b32 v11, v10
    s_waitcnt lgkmcnt(0)
    v_readfirstlane_b32 s63, v11
    s_add_u32 s98, s98, 1
    s_cmp_ge_u32 s63, s90
    s_cbranch_scc1 L_s4_14_d
    s_cmp_lt_u32 s98, 0x100000
    s_cbranch_scc1 L_s4_14
L_s4_14_d:
    ds_read_b128 v[32:35], v7 offset:0
    ds_read_b128 v[36:39], v7 offset:8192
    ds_read_b128 v[40:43], v7 offset:16384
    ds_read_b128 v[44:47], v7 offset:24576
    ds_read_b128 v[48:51], v7 offset:1024
    ds_read_b128 v[52:55], v7 offset:9216
    ds_read_b128 v[56:59], v7 offset:17408
    ds_read_b128 v[60:63], v7 offset:25600
    v_lshlrev_b32 v64, 16, v16
    v_and_b32 v65, 0xffff0000, v16
    v_lshlrev_b32 v66, 16, v17
    v_and_b32 v67, 0xffff0000, v17
    v_lshlrev_b32 v68, 16, v18
    v_and_b32 v69, 0xffff0000, v18
    v_lshlrev_b32 v70, 16, v19
    v_and_b32 v71, 0xffff0000, v19
    v_lshlrev_b32 v72, 16, v20
    v_and_b32 v73, 0xffff0000, v20
    v_lshlrev_b32 v74, 16, v21
    v_and_b32 v75, 0xffff0000, v21
    v_lshlrev_b32 v76, 16, v22
    v_and_b32 v77, 0xffff0000, v22
    v_lshlrev_b32 v78, 16, v23
    v_and_b32 v79, 0xffff0000, v23
    s_lshl_b32 s54, s4, 5
    s_add_u32 s54, s54, s5
    s_lshl_b32 s54, s54, 13
    s_add_u32 s54, s54, 3145728
    v_lshlrev_b32 v8, 2, v8
    s_waitcnt lgkmcnt(0)
    v_add_f32 v32, v32, v36
    v_add_f32 v33, v33, v37
    v_add_f32 v34, v34, v38
    v_add_f32 v35, v35, v39
    v_fmac_f32 v32, s93, v67
    v_fmac_f32 v33, s93, v66
    v_fmac_f32 v34, s93, v65
    v_fmac_f32 v35, s93, v64
    v_add_f32 v40, v40, v44
    v_add_f32 v41, v41, v45
    v_add_f32 v42, v42, v46
    v_add_f32 v43, v43, v47
    v_fmac_f32 v40, s94, v71
    v_fmac_f32 v41, s94, v70
    v_fmac_f32 v42, s94, v69
    v_fmac_f32 v43, s94, v68
    v_cvt_pk_bf16_f32 v80, v32, v40
    v_cvt_pk_bf16_f32 v81, v33, v41
    v_cvt_pk_bf16_f32 v82, v34, v42
    v_cvt_pk_bf16_f32 v83, v35, v43
    v_add_f32 v48, v48, v52
    v_add_f32 v49, v49, v53
    v_add_f32 v50, v50, v54
    v_add_f32 v51, v51, v55
    v_fmac_f32 v48, s93, v75
    v_fmac_f32 v49, s93, v74
    v_fmac_f32 v50, s93, v73
    v_fmac_f32 v51, s93, v72
    v_add_f32 v56, v56, v60
    v_add_f32 v57, v57, v61
    v_add_f32 v58, v58, v62
    v_add_f32 v59, v59, v63
    v_fmac_f32 v56, s94, v79
    v_fmac_f32 v57, s94, v78
    v_fmac_f32 v58, s94, v77
    v_fmac_f32 v59, s94, v76
    v_cvt_pk_bf16_f32 v84, v48, v56
    v_cvt_pk_bf16_f32 v85, v49, v57
    v_cvt_pk_bf16_f32 v86, v50, v58
    v_cvt_pk_bf16_f32 v87, v51, v59
    buffer_store_dwordx4 v[80:83], v8, s[8:11], s54 offen sc1
    buffer_store_dwordx4 v[84:87], v8, s[8:11], s54 offen offset:1024 sc1
    s_branch L_fin1
L_helper:
    s_lshl_b32 s16, s2, 2
    s_and_b32 s54, s6, 3
    s_add_u32 s16, s16, s54
    s_add_u32 s20, s16, 1024
    s_add_u32 s24, s16, 2048
    v_mov_b32 v10, 64784
    s_mov_b32 s98, 0
L_ls_15:
    ds_read_b32 v11, v10
    s_waitcnt lgkmcnt(0)
    v_readfirstlane_b32 s63, v11
    s_add_u32 s98, s98, 1
    s_cmp_ge_u32 s63, 8
    s_cbranch_scc1 L_ls_15_d
    s_cmp_lt_u32 s98, 0x100000
    s_cbranch_scc1 L_ls_15
L_ls_15_d:
    s_cmp_ge_u32 s16, 1376
    s_cbranch_scc1 L_f2_16
    s_mul_hi_u32 s54, s16, 0x5f417d1
    s_mul_i32 s55, s54, 43
    s_sub_u32 s55, s16, s55
    s_mul_i32 s56, s54, 44032
    s_lshl_b32 s57, s55, 6
    s_add_u32 s56, s56, s57
    v_lshrrev_b32 v128, 2, v0
    v_and_b32 v129, 3, v0
    v_mul_u32_u24 v130, 2752, v128
    v_lshl_add_u32 v130, v129, 4, v130
    buffer_load_dwordx4 v[120:123], v130, s[32:35], s56 offen
    buffer_load_dwordx4 v[124:127], v130, s[36:39], s56 offen
    v_lshlrev_b32 v128, 7, v128
    v_lshl_add_u32 v128, v129, 4, v128
    s_lshl_b32 s55, s55, 6
    s_add_u32 s55, s55, s54
    s_lshl_b32 s55, s55, 10
    s_add_u32 s16, s55, 26214400
    s_mov_b32 s17, 32768
    s_mov_b32 s18, 64
    v_lshrrev_b32 v129, 5, v0
    v_lshlrev_b32 v129, 3, v129
    v_bfe_u32 v130, v0, 2, 2
    v_add_u32 v129, v129, v130
    v_lshlrev_b32 v129, 7, v129
    v_bfe_u32 v130, v0, 4, 1
    v_lshl_add_u32 v129, v130, 6, v129
    s_mov_b32 s19, 0x00200200
    s_branch L_f2_16_e
L_f2_16:
    s_sub_u32 s54, s16, 1376
    s_lshr_b32 s55, s54, 3
    s_and_b32 s54, s54, 7
    s_lshl_b32 s56, s55, 14
    s_lshl_b32 s57, s54, 7
    s_add_u32 s56, s56, s57
    s_add_u32 s57, s56, 8192
    v_lshrrev_b32 v128, 3, v0
    v_and_b32 v129, 7, v0
    v_lshlrev_b32 v130, 10, v128
    v_lshl_add_u32 v130, v129, 4, v130
    buffer_load_dwordx4 v[120:123], v130, s[40:43], s56 offen
    buffer_load_dwordx4 v[124:127], v130, s[40:43], s57 offen
    v_lshlrev_b32 v128, 7, v128
    v_lshl_add_u32 v128, v129, 4, v128
    s_mul_i32 s54, s54, 172
    s_add_u32 s54, s54, s55
    s_lshl_b32 s54, s54, 10
    s_add_u32 s16, s54, 29360128
    s_mov_b32 s17, 88064
    s_mov_b32 s18, 1024
    v_lshrrev_b32 v129, 5, v0
    v_lshlrev_b32 v129, 2, v129
    v_bfe_u32 v130, v0, 2, 2
    v_add_u32 v129, v129, v130
    v_lshlrev_b32 v129, 7, v129
    v_bfe_u32 v130, v0, 4, 1
    v_lshl_add_u32 v129, v130, 5, v129
    s_mov_b32 s19, 0x00400400
L_f2_16_e:
    v_and_b32 v130, 3, v0
    v_lshl_add_u32 v129, v130, 3, v129
    s_cmp_ge_u32 s20, 1376
    s_cbranch_scc1 L_f2_17
    s_mul_hi_u32 s54, s20, 0x5f417d1
    s_mul_i32 s55, s54, 43
    s_sub_u32 s55, s20, s55
    s_mul_i32 s56, s54, 44032
    s_lshl_b32 s57, s55, 6
    s_add_u32 s56, s56, s57
    v_lshrrev_b32 v140, 2, v0
    v_and_b32 v141, 3, v0
    v_mul_u32_u24 v142, 2752, v140
    v_lshl_add_u32 v142, v141, 4, v142
    buffer_load_dwordx4 v[132:135], v142, s[32:35], s56 offen
    buffer_load_dwordx4 v[136:139], v142, s[36:39], s56 offen
    v_lshlrev_b32 v140, 7, v140
    v_lshl_add_u32 v140, v141, 4, v140
    s_lshl_b32 s55, s55, 6
    s_add_u32 s55, s55, s54
    s_lshl_b32 s55, s55, 10
    s_add_u32 s20, s55, 26214400
    s_mov_b32 s21, 32768
    s_mov_b32 s22, 64
    v_lshrrev_b32 v141, 5, v0
    v_lshlrev_b32 v141, 3, v141
    v_bfe_u32 v142, v0, 2, 2
    v_add_u32 v141, v141, v142
    v_lshlrev_b32 v141, 7, v141
    v_bfe_u32 v142, v0, 4, 1
    v_lshl_add_u32 v141, v142, 6, v141
    s_mov_b32 s23, 0x00200200
    s_branch L_f2_17_e
L_f2_17:
    s_sub_u32 s54, s20, 1376
    s_lshr_b32 s55, s54, 3
    s_and_b32 s54, s54, 7
    s_lshl_b32 s56, s55, 14
    s_lshl_b32 s57, s54, 7
    s_add_u32 s56, s56, s57
    s_add_u32 s57, s56, 8192
    v_lshrrev_b32 v140, 3, v0
    v_and_b32 v141, 7, v0
    v_lshlrev_b32 v142, 10, v140
    v_lshl_add_u32 v142, v141, 4, v142
    buffer_load_dwordx4 v[132:135], v142, s[40:43], s56 offen
    buffer_load_dwordx4 v[136:139], v142, s[40:43], s57 offen
    v_lshlrev_b32 v140, 7, v140
    v_lshl_add_u32 v140, v141, 4, v140
    s_mul_i32 s54, s54, 172
    s_add_u32 s54, s54, s55
    s_lshl_b32 s54, s54, 10
    s_add_u32 s20, s54, 29360128
    s_mov_b32 s21, 88064
    s_mov_b32 s22, 1024
    v_lshrrev_b32 v141, 5, v0
    v_lshlrev_b32 v141, 2, v141
    v_bfe_u32 v142, v0, 2, 2
    v_add_u32 v141, v141, v142
    v_lshlrev_b32 v141, 7, v141
    v_bfe_u32 v142, v0, 4, 1
    v_lshl_add_u32 v141, v142, 5, v141
    s_mov_b32 s23, 0x00400400
L_f2_17_e:
    v_and_b32 v142, 3, v0
    v_lshl_add_u32 v141, v142, 3, v141
    s_cmp_ge_u32 s2, 4
    s_cbranch_scc1 L_fc_18
    s_cmp_ge_u32 s24, 1376
    s_cbranch_scc1 L_f2_19
    s_mul_hi_u32 s54, s24, 0x5f417d1
    s_mul_i32 s55, s54, 43
    s_sub_u32 s55, s24, s55
    s_mul_i32 s56, s54, 44032
    s_lshl_b32 s57, s55, 6
    s_add_u32 s56, s56, s57
    v_lshrrev_b32 v168, 2, v0
    v_and_b32 v169, 3, v0
    v_mul_u32_u24 v170, 2752, v168
    v_lshl_add_u32 v170, v169, 4, v170
    buffer_load_dwordx4 v[160:163], v170, s[32:35], s56 offen
    buffer_load_dwordx4 v[164:167], v170, s[36:39], s56 offen
    v_lshlrev_b32 v168, 7, v168
    v_lshl_add_u32 v168, v169, 4, v168
    s_lshl_b32 s55, s55, 6
    s_add_u32 s55, s55, s54
    s_lshl_b32 s55, s55, 10
    s_add_u32 s24, s55, 26214400
    s_mov_b32 s25, 32768
    s_mov_b32 s26, 64
    v_lshrrev_b32 v169, 5, v0
    v_lshlrev_b32 v169, 3, v169
    v_bfe_u32 v170, v0, 2, 2
    v_add_u32 v169, v169, v170
    v_lshlrev_b32 v169, 7, v169
    v_bfe_u32 v170, v0, 4, 1
    v_lshl_add_u32 v169, v170, 6, v169
    s_mov_b32 s27, 0x00200200
    s_branch L_f2_19_e
L_f2_19:
    s_sub_u32 s54, s24, 1376
    s_lshr_b32 s55, s54, 3
    s_and_b32 s54, s54, 7
    s_lshl_b32 s56, s55, 14
    s_lshl_b32 s57, s54, 7
    s_add_u32 s56, s56, s57
    s_add_u32 s57, s56, 8192
    v_lshrrev_b32 v168, 3, v0
    v_and_b32 v169, 7, v0
    v_lshlrev_b32 v170, 10, v168
    v_lshl_add_u32 v170, v169, 4, v170
    buffer_load_dwordx4 v[160:163], v170, s[40:43], s56 offen
    buffer_load_dwordx4 v[164:167], v170, s[40:43], s57 offen
    v_lshlrev_b32 v168, 7, v168
    v_lshl_add_u32 v168, v169, 4, v168
    s_mul_i32 s54, s54, 172
    s_add_u32 s54, s54, s55
    s_lshl_b32 s54, s54, 10
    s_add_u32 s24, s54, 29360128
    s_mov_b32 s25, 88064
    s_mov_b32 s26, 1024
    v_lshrrev_b32 v169, 5, v0
    v_lshlrev_b32 v169, 2, v169
    v_bfe_u32 v170, v0, 2, 2
    v_add_u32 v169, v169, v170
    v_lshlrev_b32 v169, 7, v169
    v_bfe_u32 v170, v0, 4, 1
    v_lshl_add_u32 v169, v170, 5, v169
    s_mov_b32 s27, 0x00400400
L_f2_19_e:
    v_and_b32 v170, 3, v0
    v_lshl_add_u32 v169, v170, 3, v169
L_fc_18:
    s_cmp_lg_u32 s6, 4
    s_cbranch_scc1 L_zh_20
    s_lshl_b32 s54, s4, 5
    s_add_u32 s54, s54, s5
    s_lshl_b32 s54, s54, 7
    s_add_u32 s54, s54, 131072
    v_mov_b32 v12, 0
    v_lshlrev_b32 v13, 2, v0
    s_mov_b32 exec_hi, 0
    buffer_store_dword v12, v13, s[8:11], s54 offen sc1
    s_mov_b32 exec_hi, -1
L_zh_20:
    s_waitcnt vmcnt(0)
    s_and_b32 s54, s6, 3
    s_lshl_b32 s54, s54, 11
    s_add_u32 s54, s54, 42496
    v_add_u32 v128, s54, v128
    v_add_u32 v129, s54, v129
    v_add_u32 v130, s18, v128
    ds_write_b128 v128, v[120:123]
    ds_write_b128 v130, v[124:127]
    s_and_b32 s54, s19, 0xffff
    s_lshr_b32 s55, s19, 16
    v_add_u32 v130, s54, v129
    v_add_u32 v131, s55, v129
    v_add_u32 v128, s54, v131
    s_waitcnt lgkmcnt(0)
    ds_read_b64_tr_b16 v[120:121], v129
    ds_read_b64_tr_b16 v[122:123], v130
    ds_read_b64_tr_b16 v[124:125], v131
    ds_read_b64_tr_b16 v[126:127], v128
    s_add_u32 s54, s16, s17
    s_waitcnt lgkmcnt(0)
    buffer_store_dwordx4 v[120:123], v1, s[8:11], s16 offen sc1
    buffer_store_dwordx4 v[124:127], v1, s[8:11], s54 offen sc1
    s_and_b32 s54, s6, 3
    s_lshl_b32 s54, s54, 11
    s_add_u32 s54, s54, 42496
    v_add_u32 v140, s54, v140
    v_add_u32 v141, s54, v141
    v_add_u32 v142, s22, v140
    ds_write_b128 v140, v[132:135]
    ds_write_b128 v142, v[136:139]
    s_and_b32 s54, s23, 0xffff
    s_lshr_b32 s55, s23, 16
    v_add_u32 v142, s54, v141
    v_add_u32 v143, s55, v141
    v_add_u32 v140, s54, v143
    s_waitcnt lgkmcnt(0)
    ds_read_b64_tr_b16 v[132:133], v141
    ds_read_b64_tr_b16 v[134:135], v142
    ds_read_b64_tr_b16 v[136:137], v143
    ds_read_b64_tr_b16 v[138:139], v140
    s_add_u32 s54, s20, s21
    s_waitcnt lgkmcnt(0)
    buffer_store_dwordx4 v[132:135], v1, s[8:11], s20 offen sc1
    buffer_store_dwordx4 v[136:139], v1, s[8:11], s54 offen sc1
    s_cmp_ge_u32 s2, 4
    s_cbranch_scc1 L_fc_21
    s_and_b32 s54, s6, 3
    s_lshl_b32 s54, s54, 11
    s_add_u32 s54, s54, 42496
    v_add_u32 v168, s54, v168
    v_add_u32 v169, s54, v169
    v_add_u32 v170, s26, v168
    ds_write_b128 v168, v[160:163]
    ds_write_b128 v170, v[164:167]
    s_and_b32 s54, s27, 0xffff
    s_lshr_b32 s55, s27, 16
    v_add_u32 v170, s54, v169
    v_add_u32 v171, s55, v169
    v_add_u32 v168, s54, v171
    s_waitcnt lgkmcnt(0)
    ds_read_b64_tr_b16 v[160:161], v169
    ds_read_b64_tr_b16 v[162:163], v170
    ds_read_b64_tr_b16 v[164:165], v171
    ds_read_b64_tr_b16 v[166:167], v168
    s_add_u32 s54, s24, s25
    s_waitcnt lgkmcnt(0)
    buffer_store_dwordx4 v[160:163], v1, s[8:11], s24 offen sc1
    buffer_store_dwordx4 v[164:167], v1, s[8:11], s54 offen sc1
L_fc_21:
L_fin1:
L_end:
    s_endpgm
.text
.globl interleave_layers__ssm_conv_h3__glu_gated_swiglu__prompt_kernel
.p2align 8
.type interleave_layers__ssm_conv_h3__glu_gated_swiglu__prompt_kernel,@function
interleave_layers__ssm_conv_h3__glu_gated_swiglu__prompt_kernel:
    s_cmp_ge_u32 s2, 256
    s_cbranch_scc1 L_end2
    s_load_dwordx2 s[8:9], s[0:1], 96
    s_load_dwordx2 s[12:13], s[0:1], 0
    s_load_dwordx2 s[44:45], s[0:1], 80
    s_getpc_b64 s[56:57]
L_pc2:
    s_add_u32 s56, s56, L_k2_start-L_pc2
    s_addc_u32 s57, s57, 0
    s_lshr_b32 s58, s2, 3
    s_lshl_b32 s58, s58, 12
    v_lshlrev_b32 v60, 4, v0
    v_add_u32 v60, s58, v60
    s_mov_b32 s59, L_k2_end-L_k2_start-16
    v_min_u32 v60, s59, v60
    global_load_dwordx4 v[64:67], v60, s[56:57]
    v_lshrrev_b32 v2, 6, v0
    s_and_b32 s4, s2, 7
    s_lshr_b32 s5, s2, 3
    v_readfirstlane_b32 s6, v2
    v_and_b32 v0, 63, v0
    s_mov_b32 s3, 0x20000
    s_mov_b32 s10, 33554432
    s_mov_b32 s11, s3
    s_mov_b32 s14, 2097152
    s_mov_b32 s15, s3
    s_mov_b32 s46, 2097152
    s_mov_b32 s47, s3
    v_lshlrev_b32 v1, 4, v0
    s_getreg_b32 s99, hwreg(HW_REG_XCC_ID)
    s_and_b32 s99, s99, 15
    s_mul_i32 s95, s5, 3
    s_min_u32 s95, s95, 83
    s_mov_b32 s96, 0
    s_mov_b32 s94, 0
    s_mov_b32 s22, 0
    s_lshl_b32 s24, s4, 1
    s_add_u32 s24, s24, 0
    s_lshl_b32 s24, s24, 7
    s_lshl_b32 s26, s5, 2
    s_add_u32 s26, s26, s6
    s_add_u32 s26, s26, s24
    s_mov_b32 s23, 0
    s_lshl_b32 s25, s4, 1
    s_add_u32 s25, s25, 1
    s_lshl_b32 s25, s25, 7
    s_lshl_b32 s27, s5, 2
    s_add_u32 s27, s27, s6
    s_add_u32 s27, s27, s25
    v_bfe_u32 v2, v0, 2, 3
    v_lshlrev_b32 v2, 7, v2
    v_lshrrev_b32 v8, 5, v0
    v_lshl_add_u32 v2, v8, 6, v2
    v_and_b32 v9, 3, v0
    v_lshl_add_u32 v2, v9, 4, v2
    v_add_u32 v3, 65536, v1
    v_add_u32 v4, 131072, v1
    v_and_b32 v9, 31, v0
    v_lshlrev_b32 v5, 5, v9
    v_lshl_add_u32 v5, v8, 4, v5
    v_lshlrev_b32 v6, 10, v9
    v_lshl_add_u32 v6, v8, 4, v6
    v_lshrrev_b32 v7, 1, v0
    v_lshlrev_b32 v7, 10, v7
    v_and_b32 v9, 1, v0
    v_lshl_add_u32 v7, v9, 4, v7
    s_cmp_lg_u32 s6, 0
    s_cbranch_scc1 L_zc_22
    v_mov_b32 v10, 0
    v_mov_b32 v11, 64784
    ds_write_b32 v11, v10 offset:48
    ds_write_b32 v11, v10 offset:52
    ds_write_b32 v11, v10 offset:56
    ds_write_b32 v11, v10 offset:60
    ds_write_b32 v11, v10 offset:64
    ds_write_b32 v11, v10 offset:112
    ds_write_b32 v11, v10 offset:128
L_zc_22:
    s_waitcnt lgkmcnt(0)
    s_barrier
    s_cmp_lg_u32 s6, 3
    s_cbranch_scc1 L_hl_23
    s_lshl_b32 s54, s4, 5
    s_add_u32 s54, s54, s5
    s_lshl_b32 s54, s54, 7
    s_add_u32 s54, s54, 131072
    s_or_b32 s55, s99, 0x80
    v_mov_b32 v10, s55
    v_mov_b32 v11, s54
    s_mov_b64 exec, 1
    buffer_store_dword v10, v11, s[8:11], 0 offen sc1
    s_mov_b64 exec, -1
L_hl_23:
L_k2_start:
    s_lshl_b32 s54, s4, 8
    s_lshl_b32 s55, s5, 2
    s_add_u32 s54, s54, s55
    s_add_u32 s54, s54, 0
    s_add_u32 s55, s54, s6
    s_lshl_b32 s55, s55, 10
    buffer_load_dwordx4 v[240:243], v1, s[12:15], s55 offen
    s_lshl_b32 s54, s54, 2
    s_add_u32 s54, s54, 3145728
    s_lshl_b32 s56, s6, 6
    v_add_u32 v10, s56, v0
    v_lshlrev_b32 v11, 13, v10
    buffer_load_dwordx4 v[12:15], v11, s[8:11], s54 offen sc1
    s_lshl_b32 s54, s4, 8
    s_lshl_b32 s55, s5, 2
    s_add_u32 s54, s54, s55
    s_add_u32 s54, s54, 128
    s_add_u32 s55, s54, s6
    s_lshl_b32 s55, s55, 10
    buffer_load_dwordx4 v[248:251], v1, s[12:15], s55 offen
    s_lshl_b32 s54, s54, 2
    s_add_u32 s54, s54, 3145728
    buffer_load_dwordx4 v[16:19], v11, s[8:11], s54 offen sc1
    v_and_b32 v21, 31, v0
    v_lshlrev_b32 v21, 7, v21
    s_lshl_b32 s55, s4, 12
    s_add_u32 s55, s55, 131072
    v_add_u32 v21, s55, v21
    buffer_load_dword v20, v21, s[8:11], 0 offen sc1
    s_cmp_gt_u32 s5, 28
    s_cbranch_scc1 L_w13_24_a
    s_lshl_b32 s31, s95, 15
    s_add_u32 s31, s31, 26214400
    s_and_b32 s54, s6, 3
    s_mul_i32 s54, s54, 6
    s_add_u32 s54, s54, 0
    s_lshr_b32 s55, s54, 3
    s_lshl_b32 s55, s55, 5
    s_and_b32 s54, s54, 7
    s_add_u32 s54, s54, s55
    s_add_u32 s54, s54, 0
    s_lshl_b32 s54, s54, 10
    s_add_u32 m0, s54, 65536
    s_add_u32 s54, s54, s31
    buffer_load_dwordx4 v1, s[8:11], s54 offen lds
    s_and_b32 s54, s6, 3
    s_mul_i32 s54, s54, 6
    s_add_u32 s54, s54, 1
    s_lshr_b32 s55, s54, 3
    s_lshl_b32 s55, s55, 5
    s_and_b32 s54, s54, 7
    s_add_u32 s54, s54, s55
    s_add_u32 s54, s54, 0
    s_lshl_b32 s54, s54, 10
    s_add_u32 m0, s54, 65536
    s_add_u32 s54, s54, s31
    buffer_load_dwordx4 v1, s[8:11], s54 offen lds
    s_and_b32 s54, s6, 3
    s_mul_i32 s54, s54, 6
    s_add_u32 s54, s54, 2
    s_lshr_b32 s55, s54, 3
    s_lshl_b32 s55, s55, 5
    s_and_b32 s54, s54, 7
    s_add_u32 s54, s54, s55
    s_add_u32 s54, s54, 0
    s_lshl_b32 s54, s54, 10
    s_add_u32 m0, s54, 65536
    s_add_u32 s54, s54, s31
    buffer_load_dwordx4 v1, s[8:11], s54 offen lds
    s_and_b32 s54, s6, 3
    s_mul_i32 s54, s54, 6
    s_add_u32 s54, s54, 3
    s_lshr_b32 s55, s54, 3
    s_lshl_b32 s55, s55, 5
    s_and_b32 s54, s54, 7
    s_add_u32 s54, s54, s55
    s_add_u32 s54, s54, 0
    s_lshl_b32 s54, s54, 10
    s_add_u32 m0, s54, 65536
    s_add_u32 s54, s54, s31
    buffer_load_dwordx4 v1, s[8:11], s54 offen lds
    s_and_b32 s54, s6, 3
    s_mul_i32 s54, s54, 6
    s_add_u32 s54, s54, 4
    s_lshr_b32 s55, s54, 3
    s_lshl_b32 s55, s55, 5
    s_and_b32 s54, s54, 7
    s_add_u32 s54, s54, s55
    s_add_u32 s54, s54, 0
    s_lshl_b32 s54, s54, 10
    s_add_u32 m0, s54, 65536
    s_add_u32 s54, s54, s31
    buffer_load_dwordx4 v1, s[8:11], s54 offen lds
    s_and_b32 s54, s6, 3
    s_mul_i32 s54, s54, 6
    s_add_u32 s54, s54, 5
    s_lshr_b32 s55, s54, 3
    s_lshl_b32 s55, s55, 5
    s_and_b32 s54, s54, 7
    s_add_u32 s54, s54, s55
    s_add_u32 s54, s54, 0
    s_lshl_b32 s54, s54, 10
    s_add_u32 m0, s54, 65536
    s_add_u32 s54, s54, s31
    buffer_load_dwordx4 v1, s[8:11], s54 offen lds
    s_and_b32 s54, s6, 3
    s_mul_i32 s54, s54, 6
    s_add_u32 s54, s54, 0
    s_lshr_b32 s55, s54, 3
    s_lshl_b32 s55, s55, 5
    s_and_b32 s54, s54, 7
    s_add_u32 s54, s54, s55
    s_add_u32 s54, s54, 8
    s_lshl_b32 s54, s54, 10
    s_add_u32 m0, s54, 65536
    s_add_u32 s54, s54, s31
    buffer_load_dwordx4 v1, s[8:11], s54 offen lds
    s_and_b32 s54, s6, 3
    s_mul_i32 s54, s54, 6
    s_add_u32 s54, s54, 1
    s_lshr_b32 s55, s54, 3
    s_lshl_b32 s55, s55, 5
    s_and_b32 s54, s54, 7
    s_add_u32 s54, s54, s55
    s_add_u32 s54, s54, 8
    s_lshl_b32 s54, s54, 10
    s_add_u32 m0, s54, 65536
    s_add_u32 s54, s54, s31
    buffer_load_dwordx4 v1, s[8:11], s54 offen lds
    s_and_b32 s54, s6, 3
    s_mul_i32 s54, s54, 6
    s_add_u32 s54, s54, 2
    s_lshr_b32 s55, s54, 3
    s_lshl_b32 s55, s55, 5
    s_and_b32 s54, s54, 7
    s_add_u32 s54, s54, s55
    s_add_u32 s54, s54, 8
    s_lshl_b32 s54, s54, 10
    s_add_u32 m0, s54, 65536
    s_add_u32 s54, s54, s31
    buffer_load_dwordx4 v1, s[8:11], s54 offen lds
    s_and_b32 s54, s6, 3
    s_mul_i32 s54, s54, 6
    s_add_u32 s54, s54, 3
    s_lshr_b32 s55, s54, 3
    s_lshl_b32 s55, s55, 5
    s_and_b32 s54, s54, 7
    s_add_u32 s54, s54, s55
    s_add_u32 s54, s54, 8
    s_lshl_b32 s54, s54, 10
    s_add_u32 m0, s54, 65536
    s_add_u32 s54, s54, s31
    buffer_load_dwordx4 v1, s[8:11], s54 offen lds
    s_and_b32 s54, s6, 3
    s_mul_i32 s54, s54, 6
    s_add_u32 s54, s54, 4
    s_lshr_b32 s55, s54, 3
    s_lshl_b32 s55, s55, 5
    s_and_b32 s54, s54, 7
    s_add_u32 s54, s54, s55
    s_add_u32 s54, s54, 8
    s_lshl_b32 s54, s54, 10
    s_add_u32 m0, s54, 65536
    s_add_u32 s54, s54, s31
    buffer_load_dwordx4 v1, s[8:11], s54 offen lds
    s_and_b32 s54, s6, 3
    s_mul_i32 s54, s54, 6
    s_add_u32 s54, s54, 5
    s_lshr_b32 s55, s54, 3
    s_lshl_b32 s55, s55, 5
    s_and_b32 s54, s54, 7
    s_add_u32 s54, s54, s55
    s_add_u32 s54, s54, 8
    s_lshl_b32 s54, s54, 10
    s_add_u32 m0, s54, 65536
    s_add_u32 s54, s54, s31
    buffer_load_dwordx4 v1, s[8:11], s54 offen lds
    s_waitcnt vmcnt(12)
    s_branch L_w13_24_j
L_w13_24_a:
    s_waitcnt vmcnt(0)
L_w13_24_j:
    v_lshlrev_b32 v10, 2, v10
    v_add_u32 v22, 2048, v10
    ds_write_b32 v22, v12 offset:0
    ds_write_b32 v22, v13 offset:1040
    ds_write_b32 v22, v14 offset:2080
    ds_write_b32 v22, v15 offset:3120
    v_add_u32 v22, 34816, v10
    ds_write_b32 v22, v16 offset:0
    ds_write_b32 v22, v17 offset:1040
    ds_write_b32 v22, v18 offset:2080
    ds_write_b32 v22, v19 offset:3120
    v_cmp_ne_u32 vcc, 0, v20
    s_cmp_eq_u64 vcc, -1
    s_cbranch_scc1 L_md_25
    s_mov_b32 s98, 0
L_mp_26:
    buffer_load_dword v20, v21, s[8:11], 0 offen sc1
    s_waitcnt vmcnt(0)
    v_cmp_ne_u32 vcc, 0, v20
    s_add_u32 s98, s98, 1
    s_cmp_eq_u64 vcc, -1
    s_cbranch_scc1 L_md_25
    s_cmp_lt_u32 s98, 0x8000
    s_cbranch_scc1 L_mp_26
L_md_25:
    s_or_b32 s54, s99, 0x80
    v_cmp_eq_u32 vcc, s54, v20
    s_cmp_eq_u64 vcc, -1
    s_cselect_b32 s96, 1, 0
    s_waitcnt lgkmcnt(0)
    s_barrier
    s_mul_i32 s40, s6, 1040
    s_mul_i32 s42, s6, 1040
    s_add_u32 s40, s40, 2048
    s_add_u32 s42, s42, 34816
    v_add_u32 v196, s40, v1
    v_add_u32 v44, s42, v1
    ds_read_b128 v[244:247], v196
    ds_read_b128 v[252:255], v44
    v_lshlrev_b32 v160, 16, v240
    v_lshlrev_b32 v8, 16, v248
    v_and_b32 v161, 0xffff0000, v240
    v_and_b32 v9, 0xffff0000, v248
    v_lshlrev_b32 v162, 16, v241
    v_lshlrev_b32 v10, 16, v249
    v_and_b32 v163, 0xffff0000, v241
    v_and_b32 v11, 0xffff0000, v249
    v_lshlrev_b32 v164, 16, v242
    v_lshlrev_b32 v12, 16, v250
    v_and_b32 v165, 0xffff0000, v242
    v_and_b32 v13, 0xffff0000, v250
    v_lshlrev_b32 v166, 16, v243
    v_lshlrev_b32 v14, 16, v251
    v_and_b32 v167, 0xffff0000, v243
    v_and_b32 v15, 0xffff0000, v251
    v_add_f32 v184, v160, v161
    v_add_f32 v32, v8, v9
    v_mul_f32 v185, v160, v160
    v_mul_f32 v33, v8, v8
    v_add_f32 v186, v162, v163
    v_add_f32 v34, v10, v11
    v_mul_f32 v187, v161, v161
    v_mul_f32 v35, v9, v9
    v_add_f32 v188, v164, v165
    v_add_f32 v36, v12, v13
    v_fmac_f32 v185, v162, v162
    v_fmac_f32 v33, v10, v10
    v_add_f32 v189, v166, v167
    v_add_f32 v37, v14, v15
    v_fmac_f32 v187, v163, v163
    v_fmac_f32 v35, v11, v11
    v_add_f32 v184, v184, v186
    v_add_f32 v32, v32, v34
    v_fmac_f32 v185, v164, v164
    v_fmac_f32 v33, v12, v12
    v_add_f32 v188, v188, v189
    v_add_f32 v36, v36, v37
    v_fmac_f32 v187, v165, v165
    v_fmac_f32 v35, v13, v13
    v_fmac_f32 v185, v166, v166
    v_fmac_f32 v33, v14, v14
    v_fmac_f32 v187, v167, v167
    v_fmac_f32 v35, v15, v15
    v_add_f32 v184, v184, v188
    v_add_f32 v32, v32, v36
    v_add_f32 v185, v185, v187
    v_add_f32 v33, v33, v35
    s_nop 0
    s_nop 0
    v_add_f32_dpp v184, v184, v184 row_shr:1 row_mask:0xf bank_mask:0xf bound_ctrl:0
    v_add_f32_dpp v32, v32, v32 row_shr:1 row_mask:0xf bank_mask:0xf bound_ctrl:0
    v_add_f32_dpp v185, v185, v185 row_shr:1 row_mask:0xf bank_mask:0xf bound_ctrl:0
    v_add_f32_dpp v33, v33, v33 row_shr:1 row_mask:0xf bank_mask:0xf bound_ctrl:0
    s_nop 0
    s_nop 0
    v_add_f32_dpp v184, v184, v184 row_shr:2 row_mask:0xf bank_mask:0xf bound_ctrl:0
    v_add_f32_dpp v32, v32, v32 row_shr:2 row_mask:0xf bank_mask:0xf bound_ctrl:0
    v_add_f32_dpp v185, v185, v185 row_shr:2 row_mask:0xf bank_mask:0xf bound_ctrl:0
    v_add_f32_dpp v33, v33, v33 row_shr:2 row_mask:0xf bank_mask:0xf bound_ctrl:0
    s_nop 0
    s_nop 0
    v_add_f32_dpp v184, v184, v184 row_shr:4 row_mask:0xf bank_mask:0xf bound_ctrl:0
    v_add_f32_dpp v32, v32, v32 row_shr:4 row_mask:0xf bank_mask:0xf bound_ctrl:0
    v_add_f32_dpp v185, v185, v185 row_shr:4 row_mask:0xf bank_mask:0xf bound_ctrl:0
    v_add_f32_dpp v33, v33, v33 row_shr:4 row_mask:0xf bank_mask:0xf bound_ctrl:0
    s_nop 0
    s_nop 0
    v_add_f32_dpp v184, v184, v184 row_shr:8 row_mask:0xf bank_mask:0xf bound_ctrl:0
    v_add_f32_dpp v32, v32, v32 row_shr:8 row_mask:0xf bank_mask:0xf bound_ctrl:0
    v_add_f32_dpp v185, v185, v185 row_shr:8 row_mask:0xf bank_mask:0xf bound_ctrl:0
    v_add_f32_dpp v33, v33, v33 row_shr:8 row_mask:0xf bank_mask:0xf bound_ctrl:0
    s_nop 0
    s_nop 0
    v_add_f32_dpp v184, v184, v184 row_bcast:15 row_mask:0xa bank_mask:0xf
    v_add_f32_dpp v32, v32, v32 row_bcast:15 row_mask:0xa bank_mask:0xf
    v_add_f32_dpp v185, v185, v185 row_bcast:15 row_mask:0xa bank_mask:0xf
    v_add_f32_dpp v33, v33, v33 row_bcast:15 row_mask:0xa bank_mask:0xf
    s_nop 0
    s_nop 0
    v_add_f32_dpp v184, v184, v184 row_bcast:31 row_mask:0xc bank_mask:0xf
    v_add_f32_dpp v32, v32, v32 row_bcast:31 row_mask:0xc bank_mask:0xf
    v_add_f32_dpp v185, v185, v185 row_bcast:31 row_mask:0xc bank_mask:0xf
    v_add_f32_dpp v33, v33, v33 row_bcast:31 row_mask:0xc bank_mask:0xf
    s_nop 0
    s_nop 0
    v_readlane_b32 s48, v184, 63
    v_readlane_b32 s50, v32, 63
    v_readlane_b32 s49, v185, 63
    v_readlane_b32 s51, v33, 63
    s_nop 1
    s_nop 1
    v_mov_b32 v186, s48
    v_mov_b32 v34, s50
    v_mov_b32 v187, s49
    v_mov_b32 v35, s51
    v_mul_f32 v186, 0x3b000000, v186
    v_mul_f32 v34, 0x3b000000, v34
    v_mul_f32 v187, 0x3b000000, v187
    v_mul_f32 v35, 0x3b000000, v35
    v_fma_f32 v187, -v186, v186, v187
    v_fma_f32 v35, -v34, v34, v35
    v_max_f32 v187, 0, v187
    v_max_f32 v35, 0, v35
    v_add_f32 v187, 0x3727c5ac, v187
    v_add_f32 v35, 0x3727c5ac, v35
    v_rsq_f32 v187, v187
    v_rsq_f32 v35, v35
    s_nop 0
    s_nop 0
    v_mul_f32 v186, v186, v187
    v_mul_f32 v34, v34, v35
    v_fma_f32 v168, v160, v187, -v186
    v_fma_f32 v16, v8, v35, -v34
    v_fma_f32 v169, v161, v187, -v186
    v_fma_f32 v17, v9, v35, -v34
    v_fma_f32 v170, v162, v187, -v186
    v_fma_f32 v18, v10, v35, -v34
    v_fma_f32 v171, v163, v187, -v186
    v_fma_f32 v19, v11, v35, -v34
    v_fma_f32 v172, v164, v187, -v186
    v_fma_f32 v20, v12, v35, -v34
    v_fma_f32 v173, v165, v187, -v186
    v_fma_f32 v21, v13, v35, -v34
    v_fma_f32 v174, v166, v187, -v186
    v_fma_f32 v22, v14, v35, -v34
    v_fma_f32 v175, v167, v187, -v186
    v_fma_f32 v23, v15, v35, -v34
    s_waitcnt lgkmcnt(1)
    s_waitcnt lgkmcnt(0)
    v_lshlrev_b32 v176, 16, v244
    v_lshlrev_b32 v24, 16, v252
    v_and_b32 v177, 0xffff0000, v244
    v_and_b32 v25, 0xffff0000, v252
    v_lshlrev_b32 v178, 16, v245
    v_lshlrev_b32 v26, 16, v253
    v_and_b32 v179, 0xffff0000, v245
    v_and_b32 v27, 0xffff0000, v253
    v_lshlrev_b32 v180, 16, v246
    v_lshlrev_b32 v28, 16, v254
    v_and_b32 v181, 0xffff0000, v246
    v_and_b32 v29, 0xffff0000, v254
    v_lshlrev_b32 v182, 16, v247
    v_lshlrev_b32 v30, 16, v255
    v_and_b32 v183, 0xffff0000, v247
    v_and_b32 v31, 0xffff0000, v255
    v_fmac_f32 v160, v168, v176
    v_fmac_f32 v8, v16, v24
    v_fmac_f32 v161, v169, v177
    v_fmac_f32 v9, v17, v25
    v_fmac_f32 v162, v170, v178
    v_fmac_f32 v10, v18, v26
    v_fmac_f32 v163, v171, v179
    v_fmac_f32 v11, v19, v27
    v_fmac_f32 v164, v172, v180
    v_fmac_f32 v12, v20, v28
    v_fmac_f32 v165, v173, v181
    v_fmac_f32 v13, v21, v29
    v_fmac_f32 v166, v174, v182
    v_fmac_f32 v14, v22, v30
    v_fmac_f32 v167, v175, v183
    v_fmac_f32 v15, v23, v31
    v_cvt_pk_bf16_f32 v240, v160, v161
    v_cvt_pk_bf16_f32 v248, v8, v9
    v_cvt_pk_bf16_f32 v241, v162, v163
    v_cvt_pk_bf16_f32 v249, v10, v11
    v_cvt_pk_bf16_f32 v242, v164, v165
    v_cvt_pk_bf16_f32 v250, v12, v13
    v_cvt_pk_bf16_f32 v243, v166, v167
    v_cvt_pk_bf16_f32 v251, v14, v15
    v_lshlrev_b32 v160, 16, v240
    v_lshlrev_b32 v8, 16, v248
    v_and_b32 v161, 0xffff0000, v240
    v_and_b32 v9, 0xffff0000, v248
    v_lshlrev_b32 v162, 16, v241
    v_lshlrev_b32 v10, 16, v249
    v_and_b32 v163, 0xffff0000, v241
    v_and_b32 v11, 0xffff0000, v249
    v_lshlrev_b32 v164, 16, v242
    v_lshlrev_b32 v12, 16, v250
    v_and_b32 v165, 0xffff0000, v242
    v_and_b32 v13, 0xffff0000, v250
    v_lshlrev_b32 v166, 16, v243
    v_lshlrev_b32 v14, 16, v251
    v_and_b32 v167, 0xffff0000, v243
    v_and_b32 v15, 0xffff0000, v251
    v_add_f32 v184, v160, v161
    v_add_f32 v32, v8, v9
    v_mul_f32 v185, v160, v160
    v_mul_f32 v33, v8, v8
    v_add_f32 v186, v162, v163
    v_add_f32 v34, v10, v11
    v_mul_f32 v187, v161, v161
    v_mul_f32 v35, v9, v9
    v_add_f32 v188, v164, v165
    v_add_f32 v36, v12, v13
    v_fmac_f32 v185, v162, v162
    v_fmac_f32 v33, v10, v10
    v_add_f32 v189, v166, v167
    v_add_f32 v37, v14, v15
    v_fmac_f32 v187, v163, v163
    v_fmac_f32 v35, v11, v11
    v_add_f32 v184, v184, v186
    v_add_f32 v32, v32, v34
    v_fmac_f32 v185, v164, v164
    v_fmac_f32 v33, v12, v12
    v_add_f32 v188, v188, v189
    v_add_f32 v36, v36, v37
    v_fmac_f32 v187, v165, v165
    v_fmac_f32 v35, v13, v13
    v_fmac_f32 v185, v166, v166
    v_fmac_f32 v33, v14, v14
    v_fmac_f32 v187, v167, v167
    v_fmac_f32 v35, v15, v15
    v_add_f32 v184, v184, v188
    v_add_f32 v32, v32, v36
    v_add_f32 v185, v185, v187
    v_add_f32 v33, v33, v35
    s_nop 0
    s_nop 0
    v_add_f32_dpp v184, v184, v184 row_shr:1 row_mask:0xf bank_mask:0xf bound_ctrl:0
    v_add_f32_dpp v32, v32, v32 row_shr:1 row_mask:0xf bank_mask:0xf bound_ctrl:0
    v_add_f32_dpp v185, v185, v185 row_shr:1 row_mask:0xf bank_mask:0xf bound_ctrl:0
    v_add_f32_dpp v33, v33, v33 row_shr:1 row_mask:0xf bank_mask:0xf bound_ctrl:0
    s_nop 0
    s_nop 0
    v_add_f32_dpp v184, v184, v184 row_shr:2 row_mask:0xf bank_mask:0xf bound_ctrl:0
    v_add_f32_dpp v32, v32, v32 row_shr:2 row_mask:0xf bank_mask:0xf bound_ctrl:0
    v_add_f32_dpp v185, v185, v185 row_shr:2 row_mask:0xf bank_mask:0xf bound_ctrl:0
    v_add_f32_dpp v33, v33, v33 row_shr:2 row_mask:0xf bank_mask:0xf bound_ctrl:0
    s_nop 0
    s_nop 0
    v_add_f32_dpp v184, v184, v184 row_shr:4 row_mask:0xf bank_mask:0xf bound_ctrl:0
    v_add_f32_dpp v32, v32, v32 row_shr:4 row_mask:0xf bank_mask:0xf bound_ctrl:0
    v_add_f32_dpp v185, v185, v185 row_shr:4 row_mask:0xf bank_mask:0xf bound_ctrl:0
    v_add_f32_dpp v33, v33, v33 row_shr:4 row_mask:0xf bank_mask:0xf bound_ctrl:0
    s_nop 0
    s_nop 0
    v_add_f32_dpp v184, v184, v184 row_shr:8 row_mask:0xf bank_mask:0xf bound_ctrl:0
    v_add_f32_dpp v32, v32, v32 row_shr:8 row_mask:0xf bank_mask:0xf bound_ctrl:0
    v_add_f32_dpp v185, v185, v185 row_shr:8 row_mask:0xf bank_mask:0xf bound_ctrl:0
    v_add_f32_dpp v33, v33, v33 row_shr:8 row_mask:0xf bank_mask:0xf bound_ctrl:0
    s_nop 0
    s_nop 0
    v_add_f32_dpp v184, v184, v184 row_bcast:15 row_mask:0xa bank_mask:0xf
    v_add_f32_dpp v32, v32, v32 row_bcast:15 row_mask:0xa bank_mask:0xf
    v_add_f32_dpp v185, v185, v185 row_bcast:15 row_mask:0xa bank_mask:0xf
    v_add_f32_dpp v33, v33, v33 row_bcast:15 row_mask:0xa bank_mask:0xf
    s_nop 0
    s_nop 0
    v_add_f32_dpp v184, v184, v184 row_bcast:31 row_mask:0xc bank_mask:0xf
    v_add_f32_dpp v32, v32, v32 row_bcast:31 row_mask:0xc bank_mask:0xf
    v_add_f32_dpp v185, v185, v185 row_bcast:31 row_mask:0xc bank_mask:0xf
    v_add_f32_dpp v33, v33, v33 row_bcast:31 row_mask:0xc bank_mask:0xf
    s_nop 0
    s_nop 0
    v_readlane_b32 s48, v184, 63
    v_readlane_b32 s50, v32, 63
    v_readlane_b32 s49, v185, 63
    v_readlane_b32 s51, v33, 63
    s_nop 1
    s_nop 1
    v_mov_b32 v186, s48
    v_mov_b32 v34, s50
    v_mov_b32 v187, s49
    v_mov_b32 v35, s51
    v_mul_f32 v186, 0x3b000000, v186
    v_mul_f32 v34, 0x3b000000, v34
    v_mul_f32 v187, 0x3b000000, v187
    v_mul_f32 v35, 0x3b000000, v35
    v_fma_f32 v187, -v186, v186, v187
    v_fma_f32 v35, -v34, v34, v35
    v_max_f32 v187, 0, v187
    v_max_f32 v35, 0, v35
    v_add_f32 v187, 0x3727c5ac, v187
    v_add_f32 v35, 0x3727c5ac, v35
    v_rsq_f32 v187, v187
    v_rsq_f32 v35, v35
    s_nop 0
    s_nop 0
    v_mul_f32 v186, v186, v187
    v_mul_f32 v34, v34, v35
    v_fma_f32 v168, v160, v187, -v186
    v_fma_f32 v16, v8, v35, -v34
    v_fma_f32 v169, v161, v187, -v186
    v_fma_f32 v17, v9, v35, -v34
    v_fma_f32 v170, v162, v187, -v186
    v_fma_f32 v18, v10, v35, -v34
    v_fma_f32 v171, v163, v187, -v186
    v_fma_f32 v19, v11, v35, -v34
    v_fma_f32 v172, v164, v187, -v186
    v_fma_f32 v20, v12, v35, -v34
    v_fma_f32 v173, v165, v187, -v186
    v_fma_f32 v21, v13, v35, -v34
    v_fma_f32 v174, v166, v187, -v186
    v_fma_f32 v22, v14, v35, -v34
    v_fma_f32 v175, v167, v187, -v186
    v_fma_f32 v23, v15, v35, -v34
    v_cvt_pk_bf16_f32 v192, v168, v169
    v_cvt_pk_bf16_f32 v40, v16, v17
    v_cvt_pk_bf16_f32 v193, v170, v171
    v_cvt_pk_bf16_f32 v41, v18, v19
    v_cvt_pk_bf16_f32 v194, v172, v173
    v_cvt_pk_bf16_f32 v42, v20, v21
    v_cvt_pk_bf16_f32 v195, v174, v175
    v_cvt_pk_bf16_f32 v43, v22, v23
    s_mul_i32 s41, s6, 10256
    s_mul_i32 s43, s6, 10256
    s_add_u32 s41, s41, 64
    s_add_u32 s43, s43, 32832
    v_add_u32 v196, s41, v1
    v_add_u32 v44, s43, v1
    ds_write_b128 v196, v[192:195]
    ds_write_b128 v44, v[40:43]
    s_waitcnt lgkmcnt(0)
    s_waitcnt lgkmcnt(0)
    v_mov_b32 v198, 64896
    v_mov_b32 v199, 1
    s_add_u32 s22, s22, 4
    s_mov_b64 exec, 1
    ds_add_u32 v198, v199
    s_mov_b64 exec, -1
    s_mov_b32 s98, 0
L_s4_27:
    ds_read_b32 v199, v198
    s_waitcnt lgkmcnt(0)
    v_readfirstlane_b32 s61, v199
    s_add_u32 s98, s98, 1
    s_cmp_ge_u32 s61, s22
    s_cbranch_scc1 L_s4_27_d
    s_cmp_lt_u32 s98, 0x100000
    s_cbranch_scc1 L_s4_27
L_s4_27_d:
    v_mov_b32 v46, 64912
    v_mov_b32 v47, 1
    s_add_u32 s23, s23, 4
    s_mov_b64 exec, 1
    ds_add_u32 v46, v47
    s_mov_b64 exec, -1
    s_mov_b32 s98, 0
L_s4_29:
    ds_read_b32 v47, v46
    s_waitcnt lgkmcnt(0)
    v_readfirstlane_b32 s61, v47
    s_add_u32 s98, s98, 1
    s_cmp_ge_u32 s61, s23
    s_cbranch_scc1 L_s4_29_d
    s_cmp_lt_u32 s98, 0x100000
    s_cbranch_scc1 L_s4_29
L_s4_29_d:
    v_lshrrev_b32 v196, 2, v0
    v_lshrrev_b32 v44, 2, v0
    s_lshl_b32 s41, s6, 4
    s_lshl_b32 s43, s6, 4
    v_add_u32 v196, s41, v196
    v_add_u32 v44, s43, v44
    v_lshlrev_b32 v196, 4, v196
    v_lshlrev_b32 v44, 4, v44
    v_and_b32 v197, 3, v0
    v_and_b32 v45, 3, v0
    v_mul_u32_u24 v197, 10256, v197
    v_mul_u32_u24 v45, 10256, v45
    v_add_u32 v196, v196, v197
    v_add_u32 v44, v44, v45
    v_add_u32 v196, 64, v196
    v_add_u32 v44, 32832, v44
    ds_read_b128 v[192:195], v196
    ds_read_b128 v[40:43], v44
    s_lshl_b32 s41, s4, 3
    s_lshl_b32 s43, s4, 3
    s_lshr_b32 s40, s5, 3
    s_lshr_b32 s42, s5, 3
    s_add_u32 s41, s41, s40
    s_add_u32 s43, s43, s42
    s_add_u32 s41, s41, 0
    s_add_u32 s43, s43, 4
    s_lshl_b32 s41, s41, 15
    s_lshl_b32 s43, s43, 15
    s_and_b32 s40, s5, 7
    s_and_b32 s42, s5, 7
    s_lshl_b32 s40, s40, 7
    s_lshl_b32 s42, s42, 7
    s_add_u32 s41, s41, s40
    s_add_u32 s43, s43, s42
    s_lshl_b32 s40, s6, 13
    s_lshl_b32 s42, s6, 13
    s_add_u32 s41, s41, s40
    s_add_u32 s43, s43, s42
    s_add_u32 s41, s41, 5242880
    s_add_u32 s43, s43, 5242880
    v_lshrrev_b32 v196, 3, v0
    v_lshrrev_b32 v44, 3, v0
    v_lshlrev_b32 v196, 10, v196
    v_lshlrev_b32 v44, 10, v44
    v_and_b32 v197, 7, v0
    v_and_b32 v45, 7, v0
    v_lshl_add_u32 v196, v197, 4, v196
    v_lshl_add_u32 v44, v45, 4, v44
    s_waitcnt lgkmcnt(0)
    s_cmp_eq_u32 s94, 0
    s_cbranch_scc1 L_hs_28
    buffer_store_dwordx4 v[192:195], v196, s[8:11], s41 offen
    s_branch L_hs_28_e
L_hs_28:
    buffer_store_dwordx4 v[192:195], v196, s[8:11], s41 offen sc1
L_hs_28_e:
    s_cmp_eq_u32 s94, 0
    s_cbranch_scc1 L_hs_30
    buffer_store_dwordx4 v[40:43], v44, s[8:11], s43 offen
    s_branch L_hs_30_e
L_hs_30:
    buffer_store_dwordx4 v[40:43], v44, s[8:11], s43 offen sc1
L_hs_30_e:
    s_waitcnt vmcnt(1)
    v_mov_b32 v214, 1
    v_mov_b32 v215, s26
    s_mov_b64 exec, 1
    s_cmp_eq_u32 s96, 0
    s_cbranch_scc1 L_hs_31
    buffer_store_byte v214, v215, s[8:11], 0 offen
    s_branch L_hs_31_e
L_hs_31:
    buffer_store_byte v214, v215, s[8:11], 0 offen sc1
L_hs_31_e:
    s_mov_b64 exec, -1
    s_waitcnt vmcnt(1)
    v_mov_b32 v214, 1
    v_mov_b32 v215, s27
    s_mov_b64 exec, 1
    s_cmp_eq_u32 s96, 0
    s_cbranch_scc1 L_hs_32
    buffer_store_byte v214, v215, s[8:11], 0 offen
    s_branch L_hs_32_e
L_hs_32:
    buffer_store_byte v214, v215, s[8:11], 0 offen sc1
L_hs_32_e:
    s_mov_b64 exec, -1
    v_mov_b32 v60, 64832
    v_mov_b32 v61, 1
    s_mov_b64 exec, 1
    ds_add_u32 v60, v61
    s_mov_b64 exec, -1
    v_mov_b32 v60, 64836
    v_mov_b32 v61, 1
    s_mov_b64 exec, 1
    ds_add_u32 v60, v61
    s_mov_b64 exec, -1
    s_waitcnt vmcnt(0) lgkmcnt(0)
    s_lshl_b32 s12, s4, 3
    s_add_u32 s12, s12, s6
    s_add_u32 s12, s12, 0
    s_mul_i32 s16, s12, 86
    s_add_u32 s16, s16, s95
    s_lshl_b32 s16, s16, 10
    s_add_u32 s16, s16, 13631488
    s_lshl_b32 s12, s12, 15
    s_add_u32 s12, s12, 5242880
    s_lshl_b32 s14, s4, 3
    s_lshr_b32 s62, s5, 3
    s_add_u32 s14, s14, s62
    s_add_u32 s14, s14, 0
    s_lshl_b32 s20, s14, 4
    s_and_b32 s62, s5, 7
    s_lshl_b32 s62, s62, 1
    s_add_u32 s20, s20, s62
    s_lshl_b32 s20, s20, 1
    s_add_u32 s20, s20, s6
    s_lshl_b32 s20, s20, 10
    s_lshl_b32 s32, s14, 15
    s_and_b32 s62, s5, 7
    s_lshl_b32 s62, s62, 7
    s_add_u32 s32, s32, s62
    s_lshl_b32 s62, s6, 5
    s_add_u32 s32, s32, s62
    s_mul_i32 s14, s14, 86
    s_mul_i32 s62, s6, 22
    s_cmp_eq_u32 s6, 3
    s_subb_u32 s62, s62, 0
    s_add_u32 s14, s14, s62
    s_lshl_b32 s14, s14, 10
    s_add_u32 s14, s14, 13631488
    s_add_u32 s18, s14, 21504
    s_cmp_lt_u32 s6, 2
    s_cselect_b32 s18, s18, 33554432
    s_lshl_b32 s13, s4, 3
    s_add_u32 s13, s13, s6
    s_add_u32 s13, s13, 4
    s_mul_i32 s17, s13, 86
    s_add_u32 s17, s17, s95
    s_lshl_b32 s17, s17, 10
    s_add_u32 s17, s17, 13631488
    s_lshl_b32 s13, s13, 15
    s_add_u32 s13, s13, 5242880
    s_lshl_b32 s15, s4, 3
    s_lshr_b32 s62, s5, 3
    s_add_u32 s15, s15, s62
    s_add_u32 s15, s15, 4
    s_lshl_b32 s21, s15, 4
    s_and_b32 s62, s5, 7
    s_lshl_b32 s62, s62, 1
    s_add_u32 s21, s21, s62
    s_lshl_b32 s21, s21, 1
    s_add_u32 s21, s21, s6
    s_lshl_b32 s21, s21, 10
    s_lshl_b32 s33, s15, 15
    s_and_b32 s62, s5, 7
    s_lshl_b32 s62, s62, 7
    s_add_u32 s33, s33, s62
    s_lshl_b32 s62, s6, 5
    s_add_u32 s33, s33, s62
    s_mul_i32 s15, s15, 86
    s_mul_i32 s62, s6, 22
    s_cmp_eq_u32 s6, 3
    s_subb_u32 s62, s62, 0
    s_add_u32 s15, s15, s62
    s_lshl_b32 s15, s15, 10
    s_add_u32 s15, s15, 13631488
    s_add_u32 s19, s15, 21504
    s_cmp_lt_u32 s6, 2
    s_cselect_b32 s19, s19, 33554432
    s_cmp_gt_u32 s5, 28
    s_cbranch_scc1 L_idle_33
    s_lshl_b32 s28, s6, 3
    s_mov_b32 s29, 0x80808080
    s_lshl_b32 s28, s28, 2
    s_add_u32 s28, s28, s24
    v_and_b32 v211, 7, v0
    v_lshlrev_b32 v211, 2, v211
    v_add_u32 v211, s28, v211
    s_mov_b32 s30, 2139062143
    buffer_load_dword v210, v211, s[8:11], 0 offen sc1
    s_waitcnt vmcnt(0)
    v_add_u32 v210, s30, v210
    v_and_b32 v210, s29, v210
    v_cmp_eq_u32 vcc, s29, v210
    s_cmp_eq_u64 vcc, -1
    s_cbranch_scc1 L_cf_34_d
    s_mov_b32 s98, 0
L_cf_34:
    buffer_load_dword v210, v211, s[8:11], 0 offen sc1
    s_waitcnt vmcnt(0)
    v_add_u32 v210, s30, v210
    v_and_b32 v210, s29, v210
    v_cmp_eq_u32 vcc, s29, v210
    s_add_u32 s98, s98, 1
    s_cmp_eq_u64 vcc, -1
    s_cbranch_scc1 L_cf_34_d
    s_cmp_lt_u32 s98, 0x8000
    s_cbranch_scc1 L_cf_34
L_cf_34_d:
    buffer_load_dwordx4 a[176:179], v2, s[8:11], s12 offen offset:0 sc1
    buffer_load_dwordx4 a[180:183], v2, s[8:11], s12 offen offset:1024 sc1
    buffer_load_dwordx4 a[184:187], v2, s[8:11], s12 offen offset:2048 sc1
    buffer_load_dwordx4 a[188:191], v2, s[8:11], s12 offen offset:3072 sc1
    s_add_u32 s12, s12, 4096
    buffer_load_dwordx4 a[192:195], v2, s[8:11], s12 offen offset:0 sc1
    buffer_load_dwordx4 a[196:199], v2, s[8:11], s12 offen offset:1024 sc1
    buffer_load_dwordx4 a[200:203], v2, s[8:11], s12 offen offset:2048 sc1
    buffer_load_dwordx4 a[204:207], v2, s[8:11], s12 offen offset:3072 sc1
    s_add_u32 s12, s12, 4096
    s_and_b32 s54, s6, 3
    s_mul_i32 s54, s54, 6
    s_add_u32 s54, s54, 0
    s_lshr_b32 s55, s54, 3
    s_lshl_b32 s55, s55, 5
    s_and_b32 s54, s54, 7
    s_add_u32 s54, s54, s55
    s_add_u32 s54, s54, 16
    s_lshl_b32 s54, s54, 10
    s_add_u32 m0, s54, 65536
    s_add_u32 s54, s54, s31
    buffer_load_dwordx4 v1, s[8:11], s54 offen lds
    s_and_b32 s54, s6, 3
    s_mul_i32 s54, s54, 6
    s_add_u32 s54, s54, 1
    s_lshr_b32 s55, s54, 3
    s_lshl_b32 s55, s55, 5
    s_and_b32 s54, s54, 7
    s_add_u32 s54, s54, s55
    s_add_u32 s54, s54, 16
    s_lshl_b32 s54, s54, 10
    s_add_u32 m0, s54, 65536
    s_add_u32 s54, s54, s31
    buffer_load_dwordx4 v1, s[8:11], s54 offen lds
    s_and_b32 s54, s6, 3
    s_mul_i32 s54, s54, 6
    s_add_u32 s54, s54, 2
    s_lshr_b32 s55, s54, 3
    s_lshl_b32 s55, s55, 5
    s_and_b32 s54, s54, 7
    s_add_u32 s54, s54, s55
    s_add_u32 s54, s54, 16
    s_lshl_b32 s54, s54, 10
    s_add_u32 m0, s54, 65536
    s_add_u32 s54, s54, s31
    buffer_load_dwordx4 v1, s[8:11], s54 offen lds
    s_and_b32 s54, s6, 3
    s_mul_i32 s54, s54, 6
    s_add_u32 s54, s54, 3
    s_lshr_b32 s55, s54, 3
    s_lshl_b32 s55, s55, 5
    s_and_b32 s54, s54, 7
    s_add_u32 s54, s54, s55
    s_add_u32 s54, s54, 16
    s_lshl_b32 s54, s54, 10
    s_add_u32 m0, s54, 65536
    s_add_u32 s54, s54, s31
    buffer_load_dwordx4 v1, s[8:11], s54 offen lds
    s_and_b32 s54, s6, 3
    s_mul_i32 s54, s54, 6
    s_add_u32 s54, s54, 4
    s_lshr_b32 s55, s54, 3
    s_lshl_b32 s55, s55, 5
    s_and_b32 s54, s54, 7
    s_add_u32 s54, s54, s55
    s_add_u32 s54, s54, 16
    s_lshl_b32 s54, s54, 10
    s_add_u32 m0, s54, 65536
    s_add_u32 s54, s54, s31
    buffer_load_dwordx4 v1, s[8:11], s54 offen lds
    s_and_b32 s54, s6, 3
    s_mul_i32 s54, s54, 6
    s_add_u32 s54, s54, 5
    s_lshr_b32 s55, s54, 3
    s_lshl_b32 s55, s55, 5
    s_and_b32 s54, s54, 7
    s_add_u32 s54, s54, s55
    s_add_u32 s54, s54, 16
    s_lshl_b32 s54, s54, 10
    s_add_u32 m0, s54, 65536
    s_add_u32 s54, s54, s31
    buffer_load_dwordx4 v1, s[8:11], s54 offen lds
    s_and_b32 s54, s6, 3
    s_mul_i32 s54, s54, 6
    s_add_u32 s54, s54, 0
    s_lshr_b32 s55, s54, 3
    s_lshl_b32 s55, s55, 5
    s_and_b32 s54, s54, 7
    s_add_u32 s54, s54, s55
    s_add_u32 s54, s54, 24
    s_lshl_b32 s54, s54, 10
    s_add_u32 m0, s54, 65536
    s_add_u32 s54, s54, s31
    buffer_load_dwordx4 v1, s[8:11], s54 offen lds
    s_and_b32 s54, s6, 3
    s_mul_i32 s54, s54, 6
    s_add_u32 s54, s54, 1
    s_lshr_b32 s55, s54, 3
    s_lshl_b32 s55, s55, 5
    s_and_b32 s54, s54, 7
    s_add_u32 s54, s54, s55
    s_add_u32 s54, s54, 24
    s_lshl_b32 s54, s54, 10
    s_add_u32 m0, s54, 65536
    s_add_u32 s54, s54, s31
    buffer_load_dwordx4 v1, s[8:11], s54 offen lds
    s_and_b32 s54, s6, 3
    s_mul_i32 s54, s54, 6
    s_add_u32 s54, s54, 2
    s_lshr_b32 s55, s54, 3
    s_lshl_b32 s55, s55, 5
    s_and_b32 s54, s54, 7
    s_add_u32 s54, s54, s55
    s_add_u32 s54, s54, 24
    s_lshl_b32 s54, s54, 10
    s_add_u32 m0, s54, 65536
    s_add_u32 s54, s54, s31
    buffer_load_dwordx4 v1, s[8:11], s54 offen lds
    s_and_b32 s54, s6, 3
    s_mul_i32 s54, s54, 6
    s_add_u32 s54, s54, 3
    s_lshr_b32 s55, s54, 3
    s_lshl_b32 s55, s55, 5
    s_and_b32 s54, s54, 7
    s_add_u32 s54, s54, s55
    s_add_u32 s54, s54, 24
    s_lshl_b32 s54, s54, 10
    s_add_u32 m0, s54, 65536
    s_add_u32 s54, s54, s31
    buffer_load_dwordx4 v1, s[8:11], s54 offen lds
    s_and_b32 s54, s6, 3
    s_mul_i32 s54, s54, 6
    s_add_u32 s54, s54, 4
    s_lshr_b32 s55, s54, 3
    s_lshl_b32 s55, s55, 5
    s_and_b32 s54, s54, 7
    s_add_u32 s54, s54, s55
    s_add_u32 s54, s54, 24
    s_lshl_b32 s54, s54, 10
    s_add_u32 m0, s54, 65536
    s_add_u32 s54, s54, s31
    buffer_load_dwordx4 v1, s[8:11], s54 offen lds
    s_and_b32 s54, s6, 3
    s_mul_i32 s54, s54, 6
    s_add_u32 s54, s54, 5
    s_lshr_b32 s55, s54, 3
    s_lshl_b32 s55, s55, 5
    s_and_b32 s54, s54, 7
    s_add_u32 s54, s54, s55
    s_add_u32 s54, s54, 24
    s_lshl_b32 s54, s54, 10
    s_add_u32 m0, s54, 65536
    s_add_u32 s54, s54, s31
    buffer_load_dwordx4 v1, s[8:11], s54 offen lds
    s_mov_b32 s98, 0
L_cw_35:
    v_mov_b32 v216, 64832
    ds_read_b32 v216, v216
    s_waitcnt lgkmcnt(0)
    v_readfirstlane_b32 s59, v216
    s_add_u32 s98, s98, 1
    s_cmp_ge_u32 s59, 4
    s_cbranch_scc1 L_cw_35_d
    s_cmp_lt_u32 s98, 0x100000
    s_cbranch_scc1 L_cw_35
L_cw_35_d:
    ds_read_b128 v[104:107], v3 offset:0
    ds_read_b128 v[108:111], v3 offset:32768
    ds_read_b128 v[112:115], v4 offset:0
    ds_read_b128 v[116:119], v3 offset:1024
    ds_read_b128 v[120:123], v3 offset:33792
    ds_read_b128 v[124:127], v4 offset:1024
    s_waitcnt vmcnt(19) lgkmcnt(3)
    v_mfma_f32_32x32x16_bf16 v[8:23], v[104:107], a[176:179], 0
    ds_read_b128 v[128:131], v3 offset:2048
    buffer_load_dwordx4 a[208:211], v2, s[8:11], s12 offen offset:0 sc1
    v_mfma_f32_32x32x16_bf16 v[24:39], v[108:111], a[176:179], 0
    ds_read_b128 v[132:135], v3 offset:34816
    v_mfma_f32_32x32x16_bf16 v[40:55], v[112:115], a[176:179], 0
    ds_read_b128 v[136:139], v4 offset:2048
    s_waitcnt vmcnt(19) lgkmcnt(3)
    v_mfma_f32_32x32x16_bf16 v[8:23], v[116:119], a[180:183], v[8:23]
    ds_read_b128 v[104:107], v3 offset:3072
    buffer_load_dwordx4 a[212:215], v2, s[8:11], s12 offen offset:1024 sc1
    v_mfma_f32_32x32x16_bf16 v[24:39], v[120:123], a[180:183], v[24:39]
    ds_read_b128 v[108:111], v3 offset:35840
    s_mul_i32 s39, s6, 22
    s_cmp_eq_u32 s6, 3
    s_subb_u32 s39, s39, 0
    v_mfma_f32_32x32x16_bf16 v[40:55], v[124:127], a[180:183], v[40:55]
    ds_read_b128 v[112:115], v4 offset:3072
    s_waitcnt vmcnt(19) lgkmcnt(3)
    v_mfma_f32_32x32x16_bf16 v[8:23], v[128:131], a[184:187], v[8:23]
    ds_read_b128 v[116:119], v3 offset:4096
    buffer_load_dwordx4 a[176:179], v2, s[8:11], s12 offen offset:2048 sc1
    v_mfma_f32_32x32x16_bf16 v[24:39], v[132:135], a[184:187], v[24:39]
    ds_read_b128 v[120:123], v3 offset:36864
    v_mfma_f32_32x32x16_bf16 v[40:55], v[136:139], a[184:187], v[40:55]
    ds_read_b128 v[124:127], v4 offset:4096
    s_waitcnt vmcnt(19) lgkmcnt(3)
    v_mfma_f32_32x32x16_bf16 v[8:23], v[104:107], a[188:191], v[8:23]
    ds_read_b128 v[128:131], v3 offset:5120
    buffer_load_dwordx4 a[180:183], v2, s[8:11], s12 offen offset:3072 sc1
    s_add_u32 s12, s12, 4096
    v_mfma_f32_32x32x16_bf16 v[24:39], v[108:111], a[188:191], v[24:39]
    ds_read_b128 v[132:135], v3 offset:37888
    v_mfma_f32_32x32x16_bf16 v[40:55], v[112:115], a[188:191], v[40:55]
    ds_read_b128 v[136:139], v4 offset:5120
    s_waitcnt vmcnt(19) lgkmcnt(3)
    v_mfma_f32_32x32x16_bf16 v[8:23], v[116:119], a[192:195], v[8:23]
    ds_read_b128 v[104:107], v3 offset:6144
    buffer_load_dwordx4 a[184:187], v2, s[8:11], s12 offen offset:0 sc1
    v_mfma_f32_32x32x16_bf16 v[24:39], v[120:123], a[192:195], v[24:39]
    ds_read_b128 v[108:111], v3 offset:38912
    v_mfma_f32_32x32x16_bf16 v[40:55], v[124:127], a[192:195], v[40:55]
    ds_read_b128 v[112:115], v4 offset:6144
    s_waitcnt vmcnt(19) lgkmcnt(3)
    v_mfma_f32_32x32x16_bf16 v[8:23], v[128:131], a[196:199], v[8:23]
    ds_read_b128 v[116:119], v3 offset:7168
    buffer_load_dwordx4 a[188:191], v2, s[8:11], s12 offen offset:1024 sc1
    v_mfma_f32_32x32x16_bf16 v[24:39], v[132:135], a[196:199], v[24:39]
    ds_read_b128 v[120:123], v3 offset:39936
    v_mfma_f32_32x32x16_bf16 v[40:55], v[136:139], a[196:199], v[40:55]
    ds_read_b128 v[124:127], v4 offset:7168
    s_mov_b32 s98, 0
L_cw_36:
    v_mov_b32 v216, 64836
    ds_read_b32 v216, v216
    s_waitcnt lgkmcnt(0)
    v_readfirstlane_b32 s59, v216
    s_add_u32 s98, s98, 1
    s_cmp_ge_u32 s59, 4
    s_cbranch_scc1 L_cw_36_d
    s_cmp_lt_u32 s98, 0x100000
    s_cbranch_scc1 L_cw_36
L_cw_36_d:
    s_waitcnt vmcnt(19) lgkmcnt(3)
    v_mfma_f32_32x32x16_bf16 v[8:23], v[104:107], a[200:203], v[8:23]
    ds_read_b128 v[128:131], v3 offset:8192
    buffer_load_dwordx4 a[192:195], v2, s[8:11], s12 offen offset:2048 sc1
    v_mfma_f32_32x32x16_bf16 v[24:39], v[108:111], a[200:203], v[24:39]
    ds_read_b128 v[132:135], v3 offset:40960
    v_mfma_f32_32x32x16_bf16 v[40:55], v[112:115], a[200:203], v[40:55]
    ds_read_b128 v[136:139], v4 offset:8192
    s_and_b32 s36, s5, 7
    s_lshl_b32 s36, s36, 1
    s_add_u32 s36, s36, 0
    s_mul_i32 s36, s36, 86
    s_add_u32 s37, s36, 85
    s_add_u32 s36, s36, s39
    s_add_u32 s38, s36, 21
    s_min_u32 s38, s38, s37
    s_lshl_b32 s36, s36, 10
    s_add_u32 s36, s36, 29360128
    s_lshl_b32 s38, s38, 10
    s_add_u32 s38, s38, 29360128
    s_waitcnt vmcnt(19) lgkmcnt(3)
    v_mfma_f32_32x32x16_bf16 v[8:23], v[116:119], a[204:207], v[8:23]
    ds_read_b128 v[104:107], v3 offset:9216
    buffer_load_dwordx4 a[196:199], v2, s[8:11], s12 offen offset:3072 sc1
    s_add_u32 s12, s12, 4096
    v_mfma_f32_32x32x16_bf16 v[24:39], v[120:123], a[204:207], v[24:39]
    ds_read_b128 v[108:111], v3 offset:41984
    v_mfma_f32_32x32x16_bf16 v[40:55], v[124:127], a[204:207], v[40:55]
    ds_read_b128 v[112:115], v4 offset:9216
    s_waitcnt vmcnt(7) lgkmcnt(3)
    v_mov_b32 v216, 64840
    v_mov_b32 v217, 1
    s_mov_b64 exec, 1
    ds_add_u32 v216, v217
    s_mov_b64 exec, -1
    v_mov_b32 v216, 64844
    v_mov_b32 v217, 1
    s_mov_b64 exec, 1
    ds_add_u32 v216, v217
    s_mov_b64 exec, -1
    v_mfma_f32_32x32x16_bf16 v[8:23], v[128:131], a[208:211], v[8:23]
    ds_read_b128 v[116:119], v3 offset:10240
    buffer_load_dwordx4 a[200:203], v2, s[8:11], s12 offen offset:0 sc1
    v_mfma_f32_32x32x16_bf16 v[24:39], v[132:135], a[208:211], v[24:39]
    ds_read_b128 v[120:123], v3 offset:43008
    v_mfma_f32_32x32x16_bf16 v[40:55], v[136:139], a[208:211], v[40:55]
    ds_read_b128 v[124:127], v4 offset:10240
    s_waitcnt vmcnt(7) lgkmcnt(5)
    v_mfma_f32_32x32x16_bf16 v[8:23], v[104:107], a[212:215], v[8:23]
    ds_read_b128 v[128:131], v3 offset:11264
    buffer_load_dwordx4 a[204:207], v2, s[8:11], s12 offen offset:1024 sc1
    v_mfma_f32_32x32x16_bf16 v[24:39], v[108:111], a[212:215], v[24:39]
    ds_read_b128 v[132:135], v3 offset:44032
    v_mfma_f32_32x32x16_bf16 v[40:55], v[112:115], a[212:215], v[40:55]
    ds_read_b128 v[136:139], v4 offset:11264
    s_waitcnt vmcnt(7) lgkmcnt(3)
    v_mfma_f32_32x32x16_bf16 v[8:23], v[116:119], a[176:179], v[8:23]
    ds_read_b128 v[104:107], v3 offset:12288
    buffer_load_dwordx4 a[208:211], v2, s[8:11], s12 offen offset:2048 sc1
    v_mfma_f32_32x32x16_bf16 v[24:39], v[120:123], a[176:179], v[24:39]
    ds_read_b128 v[108:111], v3 offset:45056
    v_mfma_f32_32x32x16_bf16 v[40:55], v[124:127], a[176:179], v[40:55]
    ds_read_b128 v[112:115], v4 offset:12288
    s_waitcnt vmcnt(7) lgkmcnt(3)
    v_mfma_f32_32x32x16_bf16 v[8:23], v[128:131], a[180:183], v[8:23]
    ds_read_b128 v[116:119], v3 offset:13312
    buffer_load_dwordx4 a[212:215], v2, s[8:11], s12 offen offset:3072 sc1
    s_add_u32 s12, s12, 4096
    v_mfma_f32_32x32x16_bf16 v[24:39], v[132:135], a[180:183], v[24:39]
    ds_read_b128 v[120:123], v3 offset:46080
    buffer_load_dwordx4 a[0:3], v1, s[8:11], s36 offen offset:0
    v_mfma_f32_32x32x16_bf16 v[40:55], v[136:139], a[180:183], v[40:55]
    ds_read_b128 v[124:127], v4 offset:13312
    s_waitcnt vmcnt(8) lgkmcnt(3)
    v_mfma_f32_32x32x16_bf16 v[8:23], v[104:107], a[184:187], v[8:23]
    ds_read_b128 v[128:131], v3 offset:14336
    buffer_load_dwordx4 a[176:179], v2, s[8:11], s12 offen offset:0 sc1
    v_mfma_f32_32x32x16_bf16 v[24:39], v[108:111], a[184:187], v[24:39]
    ds_read_b128 v[132:135], v3 offset:47104
    buffer_load_dwordx4 a[4:7], v1, s[8:11], s36 offen offset:1024
    v_mfma_f32_32x32x16_bf16 v[40:55], v[112:115], a[184:187], v[40:55]
    ds_read_b128 v[136:139], v4 offset:14336
    s_waitcnt vmcnt(9) lgkmcnt(3)
    v_mfma_f32_32x32x16_bf16 v[8:23], v[116:119], a[188:191], v[8:23]
    ds_read_b128 v[104:107], v3 offset:15360
    buffer_load_dwordx4 a[180:183], v2, s[8:11], s12 offen offset:1024 sc1
    s_lshl_b32 s28, s6, 3
    s_mov_b32 s29, 0x80808080
    s_lshl_b32 s28, s28, 2
    s_add_u32 s28, s28, s25
    v_and_b32 v211, 7, v0
    v_lshlrev_b32 v211, 2, v211
    v_add_u32 v211, s28, v211
    s_mov_b32 s30, 2139062143
    buffer_load_dword v210, v211, s[8:11], 0 offen sc1
    buffer_load_dwordx4 a[8:11], v1, s[8:11], s36 offen offset:2048
    v_mfma_f32_32x32x16_bf16 v[24:39], v[120:123], a[188:191], v[24:39]
    ds_read_b128 v[108:111], v3 offset:48128
    v_mfma_f32_32x32x16_bf16 v[40:55], v[124:127], a[188:191], v[40:55]
    ds_read_b128 v[112:115], v4 offset:15360
    buffer_load_dwordx4 a[12:15], v1, s[8:11], s36 offen offset:3072
    s_mov_b32 s98, 0
L_cw_37:
    v_mov_b32 v216, 64840
    ds_read_b32 v216, v216
    s_waitcnt lgkmcnt(0)
    v_readfirstlane_b32 s59, v216
    s_add_u32 s98, s98, 1
    s_cmp_ge_u32 s59, 4
    s_cbranch_scc1 L_cw_37_d
    s_cmp_lt_u32 s98, 0x100000
    s_cbranch_scc1 L_cw_37
L_cw_37_d:
    s_waitcnt vmcnt(12) lgkmcnt(3)
    v_mfma_f32_32x32x16_bf16 v[8:23], v[128:131], a[192:195], v[8:23]
    ds_read_b128 v[116:119], v3 offset:16384
    buffer_load_dwordx4 a[184:187], v2, s[8:11], s12 offen offset:2048 sc1
    v_mfma_f32_32x32x16_bf16 v[24:39], v[132:135], a[192:195], v[24:39]
    ds_read_b128 v[120:123], v3 offset:49152
    s_add_u32 s36, s36, 4096
    v_mfma_f32_32x32x16_bf16 v[40:55], v[136:139], a[192:195], v[40:55]
    ds_read_b128 v[124:127], v4 offset:16384
    s_waitcnt vmcnt(12) lgkmcnt(3)
    v_mfma_f32_32x32x16_bf16 v[8:23], v[104:107], a[196:199], v[8:23]
    ds_read_b128 v[128:131], v3 offset:17408
    buffer_load_dwordx4 a[188:191], v2, s[8:11], s12 offen offset:3072 sc1
    s_add_u32 s12, s12, 4096
    buffer_load_dwordx4 a[16:19], v1, s[8:11], s36 offen offset:0
    v_mfma_f32_32x32x16_bf16 v[24:39], v[108:111], a[196:199], v[24:39]
    ds_read_b128 v[132:135], v3 offset:50176
    v_mfma_f32_32x32x16_bf16 v[40:55], v[112:115], a[196:199], v[40:55]
    ds_read_b128 v[136:139], v4 offset:17408
    s_waitcnt vmcnt(13) lgkmcnt(3)
    v_mfma_f32_32x32x16_bf16 v[8:23], v[116:119], a[200:203], v[8:23]
    ds_read_b128 v[104:107], v3 offset:18432
    buffer_load_dwordx4 a[192:195], v2, s[8:11], s12 offen offset:0 sc1
    buffer_load_dwordx4 a[20:23], v1, s[8:11], s36 offen offset:1024
    v_mfma_f32_32x32x16_bf16 v[24:39], v[120:123], a[200:203], v[24:39]
    ds_read_b128 v[108:111], v3 offset:51200
    v_mfma_f32_32x32x16_bf16 v[40:55], v[124:127], a[200:203], v[40:55]
    ds_read_b128 v[112:115], v4 offset:18432
    buffer_load_dwordx4 a[24:27], v1, s[8:11], s36 offen offset:2048
    s_waitcnt vmcnt(15) lgkmcnt(3)
    v_mfma_f32_32x32x16_bf16 v[8:23], v[128:131], a[204:207], v[8:23]
    ds_read_b128 v[116:119], v3 offset:19456
    buffer_load_dwordx4 a[196:199], v2, s[8:11], s12 offen offset:1024 sc1
    v_mfma_f32_32x32x16_bf16 v[24:39], v[132:135], a[204:207], v[24:39]
    ds_read_b128 v[120:123], v3 offset:52224
    buffer_load_dwordx4 a[28:31], v1, s[8:11], s36 offen offset:3072
    v_mfma_f32_32x32x16_bf16 v[40:55], v[136:139], a[204:207], v[40:55]
    ds_read_b128 v[124:127], v4 offset:19456
    s_waitcnt vmcnt(16) lgkmcnt(3)
    v_mfma_f32_32x32x16_bf16 v[8:23], v[104:107], a[208:211], v[8:23]
    ds_read_b128 v[128:131], v3 offset:20480
    buffer_load_dwordx4 a[200:203], v2, s[8:11], s12 offen offset:2048 sc1
    s_add_u32 s36, s36, 4096
    v_mfma_f32_32x32x16_bf16 v[24:39], v[108:111], a[208:211], v[24:39]
    ds_read_b128 v[132:135], v3 offset:53248
    v_mfma_f32_32x32x16_bf16 v[40:55], v[112:115], a[208:211], v[40:55]
    ds_read_b128 v[136:139], v4 offset:20480
    buffer_load_dwordx4 a[32:35], v1, s[8:11], s36 offen offset:0
    s_waitcnt vmcnt(17) lgkmcnt(3)
    v_mfma_f32_32x32x16_bf16 v[8:23], v[116:119], a[212:215], v[8:23]
    ds_read_b128 v[104:107], v3 offset:21504
    buffer_load_dwordx4 a[204:207], v2, s[8:11], s12 offen offset:3072 sc1
    s_add_u32 s12, s12, 4096
    v_mfma_f32_32x32x16_bf16 v[24:39], v[120:123], a[212:215], v[24:39]
    ds_read_b128 v[108:111], v3 offset:54272
    v_mfma_f32_32x32x16_bf16 v[40:55], v[124:127], a[212:215], v[40:55]
    ds_read_b128 v[112:115], v4 offset:21504
    buffer_load_dwordx4 a[36:39], v1, s[8:11], s36 offen offset:1024
    s_waitcnt vmcnt(17) lgkmcnt(3)
    v_mfma_f32_32x32x16_bf16 v[8:23], v[128:131], a[176:179], v[8:23]
    ds_read_b128 v[116:119], v3 offset:22528
    buffer_load_dwordx4 a[208:211], v2, s[8:11], s12 offen offset:0 sc1
    v_mfma_f32_32x32x16_bf16 v[24:39], v[132:135], a[176:179], v[24:39]
    ds_read_b128 v[120:123], v3 offset:55296
    buffer_load_dwordx4 a[40:43], v1, s[8:11], s36 offen offset:2048
    v_mfma_f32_32x32x16_bf16 v[40:55], v[136:139], a[176:179], v[40:55]
    ds_read_b128 v[124:127], v4 offset:22528
    s_waitcnt vmcnt(16)
    s_waitcnt lgkmcnt(3)
    v_mfma_f32_32x32x16_bf16 v[8:23], v[104:107], a[180:183], v[8:23]
    ds_read_b128 v[128:131], v3 offset:23552
    buffer_load_dwordx4 a[212:215], v2, s[8:11], s12 offen offset:1024 sc1
    buffer_load_dwordx4 a[44:47], v1, s[8:11], s36 offen offset:3072
    v_mfma_f32_32x32x16_bf16 v[24:39], v[108:111], a[180:183], v[24:39]
    ds_read_b128 v[132:135], v3 offset:56320
    v_mfma_f32_32x32x16_bf16 v[40:55], v[112:115], a[180:183], v[40:55]
    ds_read_b128 v[136:139], v4 offset:23552
    s_add_u32 s36, s36, 4096
    s_mov_b32 s98, 0
L_cw_38:
    v_mov_b32 v216, 64844
    ds_read_b32 v216, v216
    s_waitcnt lgkmcnt(0)
    v_readfirstlane_b32 s59, v216
    s_add_u32 s98, s98, 1
    s_cmp_ge_u32 s59, 4
    s_cbranch_scc1 L_cw_38_d
    s_cmp_lt_u32 s98, 0x100000
    s_cbranch_scc1 L_cw_38
L_cw_38_d:
    s_waitcnt vmcnt(15) lgkmcnt(3)
    v_mfma_f32_32x32x16_bf16 v[8:23], v[116:119], a[184:187], v[8:23]
    ds_read_b128 v[104:107], v3 offset:24576
    buffer_load_dwordx4 a[176:179], v2, s[8:11], s12 offen offset:2048 sc1
    v_add_u32 v210, s30, v210
    v_and_b32 v210, s29, v210
    v_cmp_eq_u32 vcc, s29, v210
    s_cmp_eq_u64 vcc, -1
    s_cbranch_scc1 L_cf_39_d
    s_mov_b32 s98, 0
L_cf_39:
    buffer_load_dword v210, v211, s[8:11], 0 offen sc1
    s_waitcnt vmcnt(0)
    v_add_u32 v210, s30, v210
    v_and_b32 v210, s29, v210
    v_cmp_eq_u32 vcc, s29, v210
    s_add_u32 s98, s98, 1
    s_cmp_eq_u64 vcc, -1
    s_cbranch_scc1 L_cf_39_d
    s_cmp_lt_u32 s98, 0x8000
    s_cbranch_scc1 L_cf_39
L_cf_39_d:
    v_mfma_f32_32x32x16_bf16 v[24:39], v[120:123], a[184:187], v[24:39]
    ds_read_b128 v[108:111], v3 offset:57344
    buffer_load_dwordx4 a[48:51], v1, s[8:11], s36 offen offset:0
    v_mfma_f32_32x32x16_bf16 v[40:55], v[124:127], a[184:187], v[40:55]
    ds_read_b128 v[112:115], v4 offset:24576
    s_waitcnt vmcnt(16) lgkmcnt(3)
    v_mfma_f32_32x32x16_bf16 v[8:23], v[128:131], a[188:191], v[8:23]
    ds_read_b128 v[116:119], v3 offset:25600
    buffer_load_dwordx4 a[180:183], v2, s[8:11], s12 offen offset:3072 sc1
    v_mfma_f32_32x32x16_bf16 v[24:39], v[132:135], a[188:191], v[24:39]
    ds_read_b128 v[120:123], v3 offset:58368
    buffer_load_dwordx4 a[52:55], v1, s[8:11], s36 offen offset:1024
    v_mfma_f32_32x32x16_bf16 v[40:55], v[136:139], a[188:191], v[40:55]
    ds_read_b128 v[124:127], v4 offset:25600
    s_waitcnt vmcnt(16) lgkmcnt(3)
    v_mfma_f32_32x32x16_bf16 v[8:23], v[104:107], a[192:195], v[8:23]
    ds_read_b128 v[128:131], v3 offset:26624
    buffer_load_dwordx4 a[184:187], v2, s[8:11], s13 offen offset:0 sc1
    buffer_load_dwordx4 a[56:59], v1, s[8:11], s36 offen offset:2048
    v_mfma_f32_32x32x16_bf16 v[24:39], v[108:111], a[192:195], v[24:39]
    ds_read_b128 v[132:135], v3 offset:59392
    v_mfma_f32_32x32x16_bf16 v[40:55], v[112:115], a[192:195], v[40:55]
    ds_read_b128 v[136:139], v4 offset:26624
    buffer_load_dwordx4 a[60:63], v1, s[8:11], s36 offen offset:3072
    s_waitcnt vmcnt(16) lgkmcnt(3)
    v_mfma_f32_32x32x16_bf16 v[8:23], v[116:119], a[196:199], v[8:23]
    ds_read_b128 v[104:107], v3 offset:27648
    buffer_load_dwordx4 a[188:191], v2, s[8:11], s13 offen offset:1024 sc1
    v_mfma_f32_32x32x16_bf16 v[24:39], v[120:123], a[196:199], v[24:39]
    ds_read_b128 v[108:111], v3 offset:60416
    s_add_u32 s36, s36, 4096
    v_mfma_f32_32x32x16_bf16 v[40:55], v[124:127], a[196:199], v[40:55]
    ds_read_b128 v[112:115], v4 offset:27648
    s_waitcnt vmcnt(15) lgkmcnt(3)
    v_mfma_f32_32x32x16_bf16 v[8:23], v[128:131], a[200:203], v[8:23]
    ds_read_b128 v[116:119], v3 offset:28672
    buffer_load_dwordx4 a[192:195], v2, s[8:11], s13 offen offset:2048 sc1
    buffer_load_dwordx4 a[64:67], v1, s[8:11], s36 offen offset:0
    v_mfma_f32_32x32x16_bf16 v[24:39], v[132:135], a[200:203], v[24:39]
    ds_read_b128 v[120:123], v3 offset:61440
    v_mfma_f32_32x32x16_bf16 v[40:55], v[136:139], a[200:203], v[40:55]
    ds_read_b128 v[124:127], v4 offset:28672
    buffer_load_dwordx4 a[68:71], v1, s[8:11], s36 offen offset:1024
    s_waitcnt vmcnt(16) lgkmcnt(3)
    v_mfma_f32_32x32x16_bf16 v[8:23], v[104:107], a[204:207], v[8:23]
    ds_read_b128 v[128:131], v3 offset:29696
    buffer_load_dwordx4 a[196:199], v2, s[8:11], s13 offen offset:3072 sc1
    s_add_u32 s13, s13, 4096
    v_mfma_f32_32x32x16_bf16 v[24:39], v[108:111], a[204:207], v[24:39]
    ds_read_b128 v[132:135], v3 offset:62464
    v_mfma_f32_32x32x16_bf16 v[40:55], v[112:115], a[204:207], v[40:55]
    ds_read_b128 v[136:139], v4 offset:29696
    buffer_load_dwordx4 a[72:75], v1, s[8:11], s36 offen offset:2048
    s_waitcnt vmcnt(16) lgkmcnt(3)
    v_mfma_f32_32x32x16_bf16 v[8:23], v[116:119], a[208:211], v[8:23]
    ds_read_b128 v[104:107], v3 offset:30720
    buffer_load_dwordx4 a[200:203], v2, s[8:11], s13 offen offset:0 sc1
    v_mfma_f32_32x32x16_bf16 v[24:39], v[120:123], a[208:211], v[24:39]
    ds_read_b128 v[108:111], v3 offset:63488
    buffer_load_dwordx4 a[76:79], v1, s[8:11], s36 offen offset:3072
    v_mfma_f32_32x32x16_bf16 v[40:55], v[124:127], a[208:211], v[40:55]
    ds_read_b128 v[112:115], v4 offset:30720
    s_waitcnt vmcnt(16) lgkmcnt(3)
    v_mfma_f32_32x32x16_bf16 v[8:23], v[128:131], a[212:215], v[8:23]
    ds_read_b128 v[116:119], v3 offset:31744
    buffer_load_dwordx4 a[204:207], v2, s[8:11], s13 offen offset:1024 sc1
    s_add_u32 s36, s36, 4096
    v_mfma_f32_32x32x16_bf16 v[24:39], v[132:135], a[212:215], v[24:39]
    ds_read_b128 v[120:123], v3 offset:64512
    v_mfma_f32_32x32x16_bf16 v[40:55], v[136:139], a[212:215], v[40:55]
    ds_read_b128 v[124:127], v4 offset:31744
    buffer_load_dwordx4 a[80:83], v1, s[8:11], s36 offen offset:0
    s_waitcnt vmcnt(16) lgkmcnt(3)
    v_mfma_f32_32x32x16_bf16 v[8:23], v[104:107], a[176:179], v[8:23]
    ds_read_b128 v[128:131], v3 offset:0
    buffer_load_dwordx4 a[208:211], v2, s[8:11], s13 offen offset:2048 sc1
    v_mfma_f32_32x32x16_bf16 v[24:39], v[108:111], a[176:179], v[24:39]
    ds_read_b128 v[132:135], v3 offset:32768
    buffer_load_dwordx4 a[84:87], v1, s[8:11], s38 offen
    v_mfma_f32_32x32x16_bf16 v[40:55], v[112:115], a[176:179], v[40:55]
    ds_read_b128 v[136:139], v4 offset:0
    s_waitcnt vmcnt(16) lgkmcnt(3)
    v_mfma_f32_32x32x16_bf16 v[8:23], v[116:119], a[180:183], v[8:23]
    ds_read_b128 v[104:107], v3 offset:1024
    buffer_load_dwordx4 a[212:215], v2, s[8:11], s13 offen offset:3072 sc1
    s_add_u32 s13, s13, 4096
    v_mfma_f32_32x32x16_bf16 v[24:39], v[120:123], a[180:183], v[24:39]
    ds_read_b128 v[108:111], v3 offset:33792
    v_mfma_f32_32x32x16_bf16 v[40:55], v[124:127], a[180:183], v[40:55]
    ds_read_b128 v[112:115], v4 offset:1024
    s_waitcnt vmcnt(15) lgkmcnt(3)
    v_mfma_f32_32x32x16_bf16 v[56:71], v[128:131], a[184:187], 0
    ds_read_b128 v[116:119], v3 offset:2048
    buffer_load_dwordx4 a[176:179], v2, s[8:11], s13 offen offset:0 sc1
    v_mfma_f32_32x32x16_bf16 v[72:87], v[132:135], a[184:187], 0
    ds_read_b128 v[120:123], v3 offset:34816
    v_mfma_f32_32x32x16_bf16 v[88:103], v[136:139], a[184:187], 0
    ds_read_b128 v[124:127], v4 offset:2048
    v_mul_f32 v140, 0xbfb8aa3b, v8
    v_mul_f32 v141, 0xbfb8aa3b, v9
    v_mul_f32 v142, 0xbfb8aa3b, v10
    v_mul_f32 v143, 0xbfb8aa3b, v11
    v_mul_f32 v144, 0xbfb8aa3b, v12
    v_mul_f32 v145, 0xbfb8aa3b, v13
    s_waitcnt vmcnt(13) lgkmcnt(3)
    v_mfma_f32_32x32x16_bf16 v[56:71], v[104:107], a[188:191], v[56:71]
    ds_read_b128 v[128:131], v3 offset:3072
    buffer_load_dwordx4 a[180:183], v2, s[8:11], s13 offen offset:1024 sc1
    v_mul_f32 v146, 0xbfb8aa3b, v14
    v_mul_f32 v147, 0xbfb8aa3b, v15
    v_exp_f32 v140, v140
    v_exp_f32 v141, v141
    v_mfma_f32_32x32x16_bf16 v[72:87], v[108:111], a[188:191], v[72:87]
    ds_read_b128 v[132:135], v3 offset:35840
    v_exp_f32 v142, v142
    v_exp_f32 v143, v143
    v_exp_f32 v144, v144
    v_exp_f32 v145, v145
    s_mul_i32 s39, s6, 22
    s_cmp_eq_u32 s6, 3
    s_subb_u32 s39, s39, 0
    v_mfma_f32_32x32x16_bf16 v[88:103], v[112:115], a[188:191], v[88:103]
    ds_read_b128 v[136:139], v4 offset:3072
    v_exp_f32 v146, v146
    v_exp_f32 v147, v147
    v_mul_f32 v16, v8, v16
    s_waitcnt vmcnt(13) lgkmcnt(3)
    v_mfma_f32_32x32x16_bf16 v[56:71], v[116:119], a[192:195], v[56:71]
    ds_read_b128 v[104:107], v3 offset:4096
    buffer_load_dwordx4 a[184:187], v2, s[8:11], s13 offen offset:2048 sc1
    v_mul_f32 v17, v9, v17
    v_mul_f32 v18, v10, v18
    v_mul_f32 v19, v11, v19
    v_mul_f32 v20, v12, v20
    v_mul_f32 v21, v13, v21
    v_mul_f32 v22, v14, v22
    v_mul_f32 v23, v15, v23
    v_mfma_f32_32x32x16_bf16 v[72:87], v[120:123], a[192:195], v[72:87]
    ds_read_b128 v[108:111], v3 offset:36864
    v_add_f32 v140, 1.0, v140
    v_add_f32 v141, 1.0, v141
    v_add_f32 v142, 1.0, v142
    v_add_f32 v143, 1.0, v143
    v_add_f32 v144, 1.0, v144
    v_add_f32 v145, 1.0, v145
    v_mfma_f32_32x32x16_bf16 v[88:103], v[124:127], a[192:195], v[88:103]
    ds_read_b128 v[112:115], v4 offset:4096
    v_add_f32 v146, 1.0, v146
    v_add_f32 v147, 1.0, v147
    v_rcp_f32 v140, v140
    v_rcp_f32 v141, v141
    s_waitcnt vmcnt(11) lgkmcnt(3)
    v_mfma_f32_32x32x16_bf16 v[56:71], v[128:131], a[196:199], v[56:71]
    ds_read_b128 v[116:119], v3 offset:5120
    buffer_load_dwordx4 a[188:191], v2, s[8:11], s13 offen offset:3072 sc1
    s_add_u32 s13, s13, 4096
    v_rcp_f32 v142, v142
    v_rcp_f32 v143, v143
    v_rcp_f32 v144, v144
    v_mfma_f32_32x32x16_bf16 v[72:87], v[132:135], a[196:199], v[72:87]
    ds_read_b128 v[120:123], v3 offset:37888
    v_rcp_f32 v145, v145
    v_rcp_f32 v146, v146
    v_rcp_f32 v147, v147
    s_nop 0
    v_mfma_f32_32x32x16_bf16 v[88:103], v[136:139], a[196:199], v[88:103]
    ds_read_b128 v[124:127], v4 offset:5120
    v_mul_f32 v16, v16, v140
    v_mul_f32 v17, v17, v141
    v_mul_f32 v18, v18, v142
    v_mul_f32 v19, v19, v143
    v_mul_f32 v20, v20, v144
    v_mul_f32 v21, v21, v145
    s_waitcnt vmcnt(10) lgkmcnt(3)
    v_mfma_f32_32x32x16_bf16 v[56:71], v[104:107], a[200:203], v[56:71]
    ds_read_b128 v[128:131], v3 offset:6144
    buffer_load_dwordx4 a[192:195], v2, s[8:11], s13 offen offset:0 sc1
    v_mul_f32 v22, v22, v146
    v_mul_f32 v23, v23, v147
    v_cvt_pk_bf16_f32 v148, v16, v17
    v_cvt_pk_bf16_f32 v149, v18, v19
    v_cvt_pk_bf16_f32 v150, v20, v21
    v_cvt_pk_bf16_f32 v151, v22, v23
    s_cmp_eq_u32 s94, 0
    s_cbranch_scc1 L_hs_40
    buffer_store_dwordx4 v[148:151], v1, s[8:11], s16 offen offset:0
    s_branch L_hs_40_e
L_hs_40:
    buffer_store_dwordx4 v[148:151], v1, s[8:11], s16 offen offset:0 sc1
L_hs_40_e:
    v_mfma_f32_32x32x16_bf16 v[72:87], v[108:111], a[200:203], v[72:87]
    ds_read_b128 v[132:135], v3 offset:38912
    v_mul_f32 v140, 0xbfb8aa3b, v24
    v_mul_f32 v141, 0xbfb8aa3b, v25
    v_mul_f32 v142, 0xbfb8aa3b, v26
    v_mul_f32 v143, 0xbfb8aa3b, v27
    v_mul_f32 v144, 0xbfb8aa3b, v28
    v_mul_f32 v145, 0xbfb8aa3b, v29
    v_mfma_f32_32x32x16_bf16 v[88:103], v[112:115], a[200:203], v[88:103]
    ds_read_b128 v[136:139], v4 offset:6144
    v_mul_f32 v146, 0xbfb8aa3b, v30
    v_mul_f32 v147, 0xbfb8aa3b, v31
    v_exp_f32 v140, v140
    v_exp_f32 v141, v141
    s_waitcnt vmcnt(10) lgkmcnt(3)
    v_mfma_f32_32x32x16_bf16 v[56:71], v[116:119], a[204:207], v[56:71]
    ds_read_b128 v[104:107], v3 offset:7168
    buffer_load_dwordx4 a[196:199], v2, s[8:11], s13 offen offset:1024 sc1
    v_exp_f32 v142, v142
    v_exp_f32 v143, v143
    v_exp_f32 v144, v144
    v_mfma_f32_32x32x16_bf16 v[72:87], v[120:123], a[204:207], v[72:87]
    ds_read_b128 v[108:111], v3 offset:39936
    v_exp_f32 v145, v145
    v_exp_f32 v146, v146
    v_exp_f32 v147, v147
    v_mul_f32 v32, v24, v32
    v_mfma_f32_32x32x16_bf16 v[88:103], v[124:127], a[204:207], v[88:103]
    ds_read_b128 v[112:115], v4 offset:7168
    v_mul_f32 v33, v25, v33
    v_mul_f32 v34, v26, v34
    v_mul_f32 v35, v27, v35
    v_mul_f32 v36, v28, v36
    v_mul_f32 v37, v29, v37
    v_mul_f32 v38, v30, v38
    s_waitcnt vmcnt(9) lgkmcnt(3)
    v_mfma_f32_32x32x16_bf16 v[56:71], v[128:131], a[208:211], v[56:71]
    ds_read_b128 v[116:119], v3 offset:8192
    buffer_load_dwordx4 a[200:203], v2, s[8:11], s13 offen offset:2048 sc1
    v_mul_f32 v39, v31, v39
    v_add_f32 v140, 1.0, v140
    v_add_f32 v141, 1.0, v141
    v_add_f32 v142, 1.0, v142
    v_add_f32 v143, 1.0, v143
    v_add_f32 v144, 1.0, v144
    v_add_f32 v145, 1.0, v145
    v_mfma_f32_32x32x16_bf16 v[72:87], v[132:135], a[208:211], v[72:87]
    ds_read_b128 v[120:123], v3 offset:40960
    v_add_f32 v146, 1.0, v146
    v_add_f32 v147, 1.0, v147
    v_rcp_f32 v140, v140
    v_rcp_f32 v141, v141
    s_and_b32 s36, s5, 7
    s_lshl_b32 s36, s36, 1
    s_add_u32 s36, s36, 1
    s_mul_i32 s36, s36, 86
    s_add_u32 s37, s36, 85
    s_add_u32 s36, s36, s39
    s_add_u32 s38, s36, 21
    s_min_u32 s38, s38, s37
    s_lshl_b32 s36, s36, 10
    s_add_u32 s36, s36, 29360128
    s_lshl_b32 s38, s38, 10
    s_add_u32 s38, s38, 29360128
    v_mfma_f32_32x32x16_bf16 v[88:103], v[136:139], a[208:211], v[88:103]
    ds_read_b128 v[124:127], v4 offset:8192
    v_rcp_f32 v142, v142
    v_rcp_f32 v143, v143
    v_rcp_f32 v144, v144
    s_waitcnt vmcnt(8) lgkmcnt(3)
    v_mfma_f32_32x32x16_bf16 v[56:71], v[104:107], a[212:215], v[56:71]
    ds_read_b128 v[128:131], v3 offset:9216
    buffer_load_dwordx4 a[204:207], v2, s[8:11], s13 offen offset:3072 sc1
    s_add_u32 s13, s13, 4096
    v_rcp_f32 v145, v145
    v_rcp_f32 v146, v146
    v_rcp_f32 v147, v147
    s_nop 0
    v_mfma_f32_32x32x16_bf16 v[72:87], v[108:111], a[212:215], v[72:87]
    ds_read_b128 v[132:135], v3 offset:41984
    v_mul_f32 v32, v32, v140
    v_mul_f32 v33, v33, v141
    v_mul_f32 v34, v34, v142
    v_mul_f32 v35, v35, v143
    v_mul_f32 v36, v36, v144
    v_mul_f32 v37, v37, v145
    v_mfma_f32_32x32x16_bf16 v[88:103], v[112:115], a[212:215], v[88:103]
    ds_read_b128 v[136:139], v4 offset:9216
    v_mul_f32 v38, v38, v146
    v_mul_f32 v39, v39, v147
    v_cvt_pk_bf16_f32 v152, v32, v33
    v_cvt_pk_bf16_f32 v153, v34, v35
    v_cvt_pk_bf16_f32 v154, v36, v37
    v_cvt_pk_bf16_f32 v155, v38, v39
    s_waitcnt vmcnt(8) lgkmcnt(3)
    v_mfma_f32_32x32x16_bf16 v[56:71], v[116:119], a[176:179], v[56:71]
    ds_read_b128 v[104:107], v3 offset:10240
    buffer_load_dwordx4 a[208:211], v2, s[8:11], s13 offen offset:0 sc1
    s_cmp_eq_u32 s94, 0
    s_cbranch_scc1 L_hs_41
    buffer_store_dwordx4 v[152:155], v1, s[8:11], s16 offen offset:1024
    s_branch L_hs_41_e
L_hs_41:
    buffer_store_dwordx4 v[152:155], v1, s[8:11], s16 offen offset:1024 sc1
L_hs_41_e:
    v_mul_f32 v140, 0xbfb8aa3b, v40
    v_mul_f32 v141, 0xbfb8aa3b, v41
    v_mul_f32 v142, 0xbfb8aa3b, v42
    v_mul_f32 v143, 0xbfb8aa3b, v43
    v_mul_f32 v144, 0xbfb8aa3b, v44
    v_mul_f32 v145, 0xbfb8aa3b, v45
    v_mfma_f32_32x32x16_bf16 v[72:87], v[120:123], a[176:179], v[72:87]
    ds_read_b128 v[108:111], v3 offset:43008
    v_mul_f32 v146, 0xbfb8aa3b, v46
    v_mul_f32 v147, 0xbfb8aa3b, v47
    v_exp_f32 v140, v140
    v_exp_f32 v141, v141
    v_mfma_f32_32x32x16_bf16 v[88:103], v[124:127], a[176:179], v[88:103]
    ds_read_b128 v[112:115], v4 offset:10240
    v_exp_f32 v142, v142
    v_exp_f32 v143, v143
    v_exp_f32 v144, v144
    s_waitcnt vmcnt(9) lgkmcnt(3)
    v_mfma_f32_32x32x16_bf16 v[56:71], v[128:131], a[180:183], v[56:71]
    ds_read_b128 v[116:119], v3 offset:11264
    buffer_load_dwordx4 a[212:215], v2, s[8:11], s13 offen offset:1024 sc1
    v_exp_f32 v145, v145
    v_exp_f32 v146, v146
    v_exp_f32 v147, v147
    v_mul_f32 v48, v40, v48
    v_mfma_f32_32x32x16_bf16 v[72:87], v[132:135], a[180:183], v[72:87]
    ds_read_b128 v[120:123], v3 offset:44032
    v_mul_f32 v49, v41, v49
    v_mul_f32 v50, v42, v50
    v_mul_f32 v51, v43, v51
    v_mul_f32 v52, v44, v52
    v_mul_f32 v53, v45, v53
    v_mul_f32 v54, v46, v54
    v_mfma_f32_32x32x16_bf16 v[88:103], v[136:139], a[180:183], v[88:103]
    ds_read_b128 v[124:127], v4 offset:11264
    v_mul_f32 v55, v47, v55
    v_add_f32 v140, 1.0, v140
    v_add_f32 v141, 1.0, v141
    v_add_f32 v142, 1.0, v142
    v_add_f32 v143, 1.0, v143
    v_add_f32 v144, 1.0, v144
    s_waitcnt vmcnt(9) lgkmcnt(3)
    v_mfma_f32_32x32x16_bf16 v[56:71], v[104:107], a[184:187], v[56:71]
    ds_read_b128 v[128:131], v3 offset:12288
    buffer_load_dwordx4 a[176:179], v2, s[8:11], s13 offen offset:2048 sc1
    v_add_f32 v145, 1.0, v145
    v_add_f32 v146, 1.0, v146
    v_add_f32 v147, 1.0, v147
    v_rcp_f32 v140, v140
    v_rcp_f32 v141, v141
    v_mfma_f32_32x32x16_bf16 v[72:87], v[108:111], a[184:187], v[72:87]
    ds_read_b128 v[132:135], v3 offset:45056
    v_rcp_f32 v142, v142
    v_rcp_f32 v143, v143
    v_rcp_f32 v144, v144
    v_mfma_f32_32x32x16_bf16 v[88:103], v[112:115], a[184:187], v[88:103]
    ds_read_b128 v[136:139], v4 offset:12288
    v_rcp_f32 v145, v145
    v_rcp_f32 v146, v146
    v_rcp_f32 v147, v147
    buffer_load_dwordx4 a[88:91], v1, s[8:11], s36 offen offset:0
    s_waitcnt vmcnt(10) lgkmcnt(3)
    v_mfma_f32_32x32x16_bf16 v[56:71], v[116:119], a[188:191], v[56:71]
    ds_read_b128 v[104:107], v3 offset:13312
    buffer_load_dwordx4 a[180:183], v2, s[8:11], s13 offen offset:3072 sc1
    s_add_u32 s13, s13, 4096
    s_nop 0
    v_mul_f32 v48, v48, v140
    v_mul_f32 v49, v49, v141
    v_mul_f32 v50, v50, v142
    v_mul_f32 v51, v51, v143
    v_mul_f32 v52, v52, v144
    v_mul_f32 v53, v53, v145
    v_mfma_f32_32x32x16_bf16 v[72:87], v[120:123], a[188:191], v[72:87]
    ds_read_b128 v[108:111], v3 offset:46080
    v_mul_f32 v54, v54, v146
    v_mul_f32 v55, v55, v147
    v_cvt_pk_bf16_f32 v156, v48, v49
    v_cvt_pk_bf16_f32 v157, v50, v51
    v_cvt_pk_bf16_f32 v158, v52, v53
    v_cvt_pk_bf16_f32 v159, v54, v55
    buffer_load_dwordx4 a[92:95], v1, s[8:11], s36 offen offset:1024
    v_mfma_f32_32x32x16_bf16 v[88:103], v[124:127], a[188:191], v[88:103]
    ds_read_b128 v[112:115], v4 offset:13312
    s_cmp_eq_u32 s94, 0
    s_cbranch_scc1 L_hs_42
    buffer_store_dwordx4 v[156:159], v1, s[8:11], s16 offen offset:2048
    s_branch L_hs_42_e
L_hs_42:
    buffer_store_dwordx4 v[156:159], v1, s[8:11], s16 offen offset:2048 sc1
L_hs_42_e:
    s_waitcnt vmcnt(0)
    v_mov_b32 v214, 2
    v_mov_b32 v215, s26
    s_mov_b64 exec, 1
    s_cmp_eq_u32 s96, 0
    s_cbranch_scc1 L_hs_43
    buffer_store_byte v214, v215, s[8:11], 0 offen
    s_branch L_hs_43_e
L_hs_43:
    buffer_store_byte v214, v215, s[8:11], 0 offen sc1
L_hs_43_e:
    s_mov_b64 exec, -1
    s_waitcnt lgkmcnt(3)
    v_mfma_f32_32x32x16_bf16 v[56:71], v[128:131], a[192:195], v[56:71]
    ds_read_b128 v[116:119], v3 offset:14336
    buffer_load_dwordx4 a[184:187], v2, s[8:11], s13 offen offset:0 sc1
    buffer_load_dwordx4 a[96:99], v1, s[8:11], s36 offen offset:2048
    v_mfma_f32_32x32x16_bf16 v[72:87], v[132:135], a[192:195], v[72:87]
    ds_read_b128 v[120:123], v3 offset:47104
    v_mfma_f32_32x32x16_bf16 v[88:103], v[136:139], a[192:195], v[88:103]
    ds_read_b128 v[124:127], v4 offset:14336
    buffer_load_dwordx4 a[100:103], v1, s[8:11], s36 offen offset:3072
    s_waitcnt lgkmcnt(3)
    v_mfma_f32_32x32x16_bf16 v[56:71], v[104:107], a[196:199], v[56:71]
    ds_read_b128 v[128:131], v3 offset:15360
    buffer_load_dwordx4 a[188:191], v2, s[8:11], s13 offen offset:1024 sc1
    v_mfma_f32_32x32x16_bf16 v[72:87], v[108:111], a[196:199], v[72:87]
    ds_read_b128 v[132:135], v3 offset:48128
    s_add_u32 s36, s36, 4096
    v_mfma_f32_32x32x16_bf16 v[88:103], v[112:115], a[196:199], v[88:103]
    ds_read_b128 v[136:139], v4 offset:15360
    s_waitcnt lgkmcnt(3)
    v_mfma_f32_32x32x16_bf16 v[56:71], v[116:119], a[200:203], v[56:71]
    ds_read_b128 v[104:107], v3 offset:16384
    buffer_load_dwordx4 a[192:195], v2, s[8:11], s13 offen offset:2048 sc1
    buffer_load_dwordx4 a[104:107], v1, s[8:11], s36 offen offset:0
    v_mfma_f32_32x32x16_bf16 v[72:87], v[120:123], a[200:203], v[72:87]
    ds_read_b128 v[108:111], v3 offset:49152
    buffer_load_dwordx4 a[108:111], v1, s[8:11], s36 offen offset:1024
    v_mfma_f32_32x32x16_bf16 v[88:103], v[124:127], a[200:203], v[88:103]
    ds_read_b128 v[112:115], v4 offset:16384
    s_waitcnt lgkmcnt(3)
    v_mfma_f32_32x32x16_bf16 v[56:71], v[128:131], a[204:207], v[56:71]
    ds_read_b128 v[116:119], v3 offset:17408
    buffer_load_dwordx4 a[196:199], v2, s[8:11], s13 offen offset:3072 sc1
    s_add_u32 s13, s13, 4096
    buffer_load_dwordx4 a[112:115], v1, s[8:11], s36 offen offset:2048
    v_mfma_f32_32x32x16_bf16 v[72:87], v[132:135], a[204:207], v[72:87]
    ds_read_b128 v[120:123], v3 offset:50176
    v_mfma_f32_32x32x16_bf16 v[88:103], v[136:139], a[204:207], v[88:103]
    ds_read_b128 v[124:127], v4 offset:17408
    buffer_load_dwordx4 a[116:119], v1, s[8:11], s36 offen offset:3072
    s_waitcnt lgkmcnt(3)
    v_mfma_f32_32x32x16_bf16 v[56:71], v[104:107], a[208:211], v[56:71]
    ds_read_b128 v[128:131], v3 offset:18432
    buffer_load_dwordx4 a[200:203], v2, s[8:11], s13 offen offset:0 sc1
    v_mfma_f32_32x32x16_bf16 v[72:87], v[108:111], a[208:211], v[72:87]
    ds_read_b128 v[132:135], v3 offset:51200
    s_add_u32 s36, s36, 4096
    v_mfma_f32_32x32x16_bf16 v[88:103], v[112:115], a[208:211], v[88:103]
    ds_read_b128 v[136:139], v4 offset:18432
    s_waitcnt lgkmcnt(3)
    v_mfma_f32_32x32x16_bf16 v[56:71], v[116:119], a[212:215], v[56:71]
    ds_read_b128 v[104:107], v3 offset:19456
    buffer_load_dwordx4 a[204:207], v2, s[8:11], s13 offen offset:1024 sc1
    buffer_load_dwordx4 a[120:123], v1, s[8:11], s36 offen offset:0
    v_mfma_f32_32x32x16_bf16 v[72:87], v[120:123], a[212:215], v[72:87]
    ds_read_b128 v[108:111], v3 offset:52224
    v_mfma_f32_32x32x16_bf16 v[88:103], v[124:127], a[212:215], v[88:103]
    ds_read_b128 v[112:115], v4 offset:19456
    buffer_load_dwordx4 a[124:127], v1, s[8:11], s36 offen offset:1024
    s_waitcnt lgkmcnt(3)
    v_mfma_f32_32x32x16_bf16 v[56:71], v[128:131], a[176:179], v[56:71]
    ds_read_b128 v[116:119], v3 offset:20480
    buffer_load_dwordx4 a[208:211], v2, s[8:11], s13 offen offset:2048 sc1
    v_mfma_f32_32x32x16_bf16 v[72:87], v[132:135], a[176:179], v[72:87]
    ds_read_b128 v[120:123], v3 offset:53248
    buffer_load_dwordx4 a[128:131], v1, s[8:11], s36 offen offset:2048
    v_mfma_f32_32x32x16_bf16 v[88:103], v[136:139], a[176:179], v[88:103]
    ds_read_b128 v[124:127], v4 offset:20480
    s_waitcnt lgkmcnt(3)
    v_mfma_f32_32x32x16_bf16 v[56:71], v[104:107], a[180:183], v[56:71]
    ds_read_b128 v[128:131], v3 offset:21504
    buffer_load_dwordx4 a[212:215], v2, s[8:11], s13 offen offset:3072 sc1
    s_add_u32 s13, s13, 4096
    buffer_load_dwordx4 a[132:135], v1, s[8:11], s36 offen offset:3072
    v_mfma_f32_32x32x16_bf16 v[72:87], v[108:111], a[180:183], v[72:87]
    ds_read_b128 v[132:135], v3 offset:54272
    v_mfma_f32_32x32x16_bf16 v[88:103], v[112:115], a[180:183], v[88:103]
    ds_read_b128 v[136:139], v4 offset:21504
    s_add_u32 s36, s36, 4096
    s_waitcnt vmcnt(17) lgkmcnt(3)
    v_mfma_f32_32x32x16_bf16 v[56:71], v[116:119], a[184:187], v[56:71]
    ds_read_b128 v[104:107], v3 offset:22528
    buffer_load_dwordx4 a[176:179], v2, s[8:11], s13 offen offset:0 sc1
    v_mfma_f32_32x32x16_bf16 v[72:87], v[120:123], a[184:187], v[72:87]
    ds_read_b128 v[108:111], v3 offset:55296
    buffer_load_dwordx4 a[136:139], v1, s[8:11], s36 offen offset:0
    v_mfma_f32_32x32x16_bf16 v[88:103], v[124:127], a[184:187], v[88:103]
    ds_read_b128 v[112:115], v4 offset:22528
    s_waitcnt vmcnt(16) lgkmcnt(3)
    v_mfma_f32_32x32x16_bf16 v[56:71], v[128:131], a[188:191], v[56:71]
    ds_read_b128 v[116:119], v3 offset:23552
    buffer_load_dwordx4 a[180:183], v2, s[8:11], s13 offen offset:1024 sc1
    buffer_load_dwordx4 a[140:143], v1, s[8:11], s36 offen offset:1024
    v_mfma_f32_32x32x16_bf16 v[72:87], v[132:135], a[188:191], v[72:87]
    ds_read_b128 v[120:123], v3 offset:56320
    v_mfma_f32_32x32x16_bf16 v[88:103], v[136:139], a[188:191], v[88:103]
    ds_read_b128 v[124:127], v4 offset:23552
    buffer_load_dwordx4 a[144:147], v1, s[8:11], s36 offen offset:2048
    s_waitcnt vmcnt(18) lgkmcnt(3)
    v_mfma_f32_32x32x16_bf16 v[56:71], v[104:107], a[192:195], v[56:71]
    ds_read_b128 v[128:131], v3 offset:24576
    buffer_load_dwordx4 a[184:187], v2, s[8:11], s13 offen offset:2048 sc1
    v_mfma_f32_32x32x16_bf16 v[72:87], v[108:111], a[192:195], v[72:87]
    ds_read_b128 v[132:135], v3 offset:57344
    buffer_load_dwordx4 a[148:151], v1, s[8:11], s36 offen offset:3072
    v_mfma_f32_32x32x16_bf16 v[88:103], v[112:115], a[192:195], v[88:103]
    ds_read_b128 v[136:139], v4 offset:24576
    s_waitcnt vmcnt(17) lgkmcnt(3)
    v_mfma_f32_32x32x16_bf16 v[56:71], v[116:119], a[196:199], v[56:71]
    ds_read_b128 v[104:107], v3 offset:25600
    buffer_load_dwordx4 a[188:191], v2, s[8:11], s13 offen offset:3072 sc1
    s_add_u32 s36, s36, 4096
    v_mfma_f32_32x32x16_bf16 v[72:87], v[120:123], a[196:199], v[72:87]
    ds_read_b128 v[108:111], v3 offset:58368
    v_mfma_f32_32x32x16_bf16 v[88:103], v[124:127], a[196:199], v[88:103]
    ds_read_b128 v[112:115], v4 offset:25600
    buffer_load_dwordx4 a[152:155], v1, s[8:11], s36 offen offset:0
    s_waitcnt vmcnt(16) lgkmcnt(3)
    v_mfma_f32_32x32x16_bf16 v[56:71], v[128:131], a[200:203], v[56:71]
    ds_read_b128 v[116:119], v3 offset:26624
    s_mul_i32 s28, s6, 7
    s_lshr_b32 s29, s5, 3
    s_lshl_b32 s29, s29, 3
    s_lshl_b32 s29, 0x80, s29
    s_lshl_b32 s28, s28, 2
    s_add_u32 s28, s28, s24
    v_and_b32 v211, 7, v0
    v_lshlrev_b32 v211, 2, v211
    v_add_u32 v211, s28, v211
    s_mov_b32 s30, 2122219134
    buffer_load_dword v210, v211, s[8:11], 0 offen sc1
    v_mfma_f32_32x32x16_bf16 v[72:87], v[132:135], a[200:203], v[72:87]
    ds_read_b128 v[120:123], v3 offset:59392
    buffer_load_dwordx4 a[156:159], v1, s[8:11], s36 offen offset:1024
    v_mfma_f32_32x32x16_bf16 v[88:103], v[136:139], a[200:203], v[88:103]
    ds_read_b128 v[124:127], v4 offset:26624
    s_waitcnt vmcnt(17) lgkmcnt(3)
    v_mfma_f32_32x32x16_bf16 v[56:71], v[104:107], a[204:207], v[56:71]
    ds_read_b128 v[128:131], v3 offset:27648
    buffer_load_dwordx4 a[160:163], v1, s[8:11], s36 offen offset:2048
    v_mfma_f32_32x32x16_bf16 v[72:87], v[108:111], a[204:207], v[72:87]
    ds_read_b128 v[132:135], v3 offset:60416
    v_mfma_f32_32x32x16_bf16 v[88:103], v[112:115], a[204:207], v[88:103]
    ds_read_b128 v[136:139], v4 offset:27648
    buffer_load_dwordx4 a[164:167], v1, s[8:11], s36 offen offset:3072
    s_waitcnt vmcnt(16) lgkmcnt(3)
    v_mfma_f32_32x32x16_bf16 v[56:71], v[116:119], a[208:211], v[56:71]
    ds_read_b128 v[104:107], v3 offset:28672
    v_mfma_f32_32x32x16_bf16 v[72:87], v[120:123], a[208:211], v[72:87]
    ds_read_b128 v[108:111], v3 offset:61440
    s_add_u32 s36, s36, 4096
    v_mfma_f32_32x32x16_bf16 v[88:103], v[124:127], a[208:211], v[88:103]
    ds_read_b128 v[112:115], v4 offset:28672
    s_waitcnt vmcnt(3)
    v_add_u32 v210, s30, v210
    v_and_b32 v210, s29, v210
    v_cmp_eq_u32 vcc, s29, v210
    s_cmp_eq_u64 vcc, -1
    s_cbranch_scc1 L_cf_44_d
    s_mov_b32 s98, 0
L_cf_44:
    buffer_load_dword v210, v211, s[8:11], 0 offen sc1
    s_waitcnt vmcnt(0)
    v_add_u32 v210, s30, v210
    v_and_b32 v210, s29, v210
    v_cmp_eq_u32 vcc, s29, v210
    s_add_u32 s98, s98, 1
    s_cmp_eq_u64 vcc, -1
    s_cbranch_scc1 L_cf_44_d
    s_cmp_lt_u32 s98, 0x8000
    s_cbranch_scc1 L_cf_44
L_cf_44_d:
    buffer_load_dwordx4 a[216:219], v1, s[8:11], s14 offen offset:0 sc1
    s_waitcnt lgkmcnt(3)
    v_mfma_f32_32x32x16_bf16 v[56:71], v[128:131], a[212:215], v[56:71]
    ds_read_b128 v[116:119], v3 offset:29696
    buffer_load_dwordx4 a[168:171], v1, s[8:11], s36 offen offset:0
    v_mfma_f32_32x32x16_bf16 v[72:87], v[132:135], a[212:215], v[72:87]
    ds_read_b128 v[120:123], v3 offset:62464
    buffer_load_dwordx4 a[220:223], v1, s[8:11], s14 offen offset:1024 sc1
    v_mfma_f32_32x32x16_bf16 v[88:103], v[136:139], a[212:215], v[88:103]
    ds_read_b128 v[124:127], v4 offset:29696
    buffer_load_dwordx4 a[172:175], v1, s[8:11], s38 offen
    s_waitcnt lgkmcnt(3)
    v_mfma_f32_32x32x16_bf16 v[56:71], v[104:107], a[176:179], v[56:71]
    ds_read_b128 v[128:131], v3 offset:30720
    buffer_load_dwordx4 a[224:227], v1, s[8:11], s14 offen offset:2048 sc1
    v_mfma_f32_32x32x16_bf16 v[72:87], v[108:111], a[176:179], v[72:87]
    ds_read_b128 v[132:135], v3 offset:63488
    v_mfma_f32_32x32x16_bf16 v[88:103], v[112:115], a[176:179], v[88:103]
    ds_read_b128 v[136:139], v4 offset:30720
    buffer_load_dwordx4 a[228:231], v1, s[8:11], s14 offen offset:3072 sc1
    s_add_u32 s14, s14, 4096
    s_waitcnt lgkmcnt(3)
    v_mfma_f32_32x32x16_bf16 v[56:71], v[116:119], a[180:183], v[56:71]
    ds_read_b128 v[104:107], v3 offset:31744
    v_mfma_f32_32x32x16_bf16 v[72:87], v[120:123], a[180:183], v[72:87]
    ds_read_b128 v[108:111], v3 offset:64512
    buffer_load_dwordx4 a[232:235], v1, s[8:11], s14 offen offset:0 sc1
    v_mfma_f32_32x32x16_bf16 v[88:103], v[124:127], a[180:183], v[88:103]
    ds_read_b128 v[112:115], v4 offset:31744
    s_waitcnt lgkmcnt(3)
    v_mfma_f32_32x32x16_bf16 v[56:71], v[128:131], a[184:187], v[56:71]
    buffer_load_dwordx4 a[236:239], v1, s[8:11], s14 offen offset:1024 sc1
    v_mfma_f32_32x32x16_bf16 v[72:87], v[132:135], a[184:187], v[72:87]
    v_mfma_f32_32x32x16_bf16 v[88:103], v[136:139], a[184:187], v[88:103]
    buffer_load_dwordx4 a[240:243], v1, s[8:11], s14 offen offset:2048 sc1
    s_waitcnt lgkmcnt(0)
    v_mfma_f32_32x32x16_bf16 v[56:71], v[104:107], a[188:191], v[56:71]
    buffer_load_dwordx4 a[244:247], v1, s[8:11], s14 offen offset:3072 sc1
    v_mfma_f32_32x32x16_bf16 v[72:87], v[108:111], a[188:191], v[72:87]
    s_add_u32 s14, s14, 4096
    v_mfma_f32_32x32x16_bf16 v[88:103], v[112:115], a[188:191], v[88:103]
    s_waitcnt vmcnt(6)
    v_mfma_f32_32x32x16_bf16 v[8:23], a[0:3], a[216:219], 0
    buffer_load_dwordx4 a[248:251], v1, s[8:11], s14 offen offset:0 sc1
    v_mfma_f32_32x32x16_bf16 v[24:39], a[88:91], a[216:219], 0
    v_mul_f32 v140, 0xbfb8aa3b, v56
    v_mul_f32 v141, 0xbfb8aa3b, v57
    v_mul_f32 v142, 0xbfb8aa3b, v58
    v_mul_f32 v143, 0xbfb8aa3b, v59
    v_mul_f32 v144, 0xbfb8aa3b, v60
    v_mfma_f32_32x32x16_bf16 v[8:23], a[4:7], a[220:223], v[8:23]
    buffer_load_dwordx4 a[252:255], v1, s[8:11], s14 offen offset:1024 sc1
    v_mul_f32 v145, 0xbfb8aa3b, v61
    v_mul_f32 v146, 0xbfb8aa3b, v62
    v_mul_f32 v147, 0xbfb8aa3b, v63
    v_exp_f32 v140, v140
    v_mfma_f32_32x32x16_bf16 v[24:39], a[92:95], a[220:223], v[24:39]
    v_exp_f32 v141, v141
    v_exp_f32 v142, v142
    v_exp_f32 v143, v143
    s_waitcnt vmcnt(7)
    v_mfma_f32_32x32x16_bf16 v[8:23], a[8:11], a[224:227], v[8:23]
    buffer_load_dwordx4 a[216:219], v1, s[8:11], s14 offen offset:2048 sc1
    v_exp_f32 v144, v144
    v_exp_f32 v145, v145
    v_mfma_f32_32x32x16_bf16 v[24:39], a[96:99], a[224:227], v[24:39]
    v_exp_f32 v146, v146
    v_exp_f32 v147, v147
    v_mul_f32 v64, v56, v64
    s_waitcnt vmcnt(7)
    v_mfma_f32_32x32x16_bf16 v[8:23], a[12:15], a[228:231], v[8:23]
    buffer_load_dwordx4 a[220:223], v1, s[8:11], s14 offen offset:3072 sc1
    s_add_u32 s14, s14, 4096
    v_mul_f32 v65, v57, v65
    v_mul_f32 v66, v58, v66
    v_mul_f32 v67, v59, v67
    v_mul_f32 v68, v60, v68
    v_mul_f32 v69, v61, v69
    v_mfma_f32_32x32x16_bf16 v[24:39], a[100:103], a[228:231], v[24:39]
    v_mul_f32 v70, v62, v70
    v_mul_f32 v71, v63, v71
    v_add_f32 v140, 1.0, v140
    v_add_f32 v141, 1.0, v141
    v_add_f32 v142, 1.0, v142
    s_waitcnt vmcnt(7)
    v_mfma_f32_32x32x16_bf16 v[8:23], a[16:19], a[232:235], v[8:23]
    buffer_load_dwordx4 a[224:227], v1, s[8:11], s14 offen offset:0 sc1
    v_add_f32 v143, 1.0, v143
    v_add_f32 v144, 1.0, v144
    v_add_f32 v145, 1.0, v145
    v_add_f32 v146, 1.0, v146
    v_add_f32 v147, 1.0, v147
    v_mfma_f32_32x32x16_bf16 v[24:39], a[104:107], a[232:235], v[24:39]
    v_rcp_f32 v140, v140
    v_rcp_f32 v141, v141
    v_rcp_f32 v142, v142
    s_waitcnt vmcnt(7)
    v_mfma_f32_32x32x16_bf16 v[8:23], a[20:23], a[236:239], v[8:23]
    buffer_load_dwordx4 a[228:231], v1, s[8:11], s14 offen offset:1024 sc1
    v_rcp_f32 v143, v143
    v_rcp_f32 v144, v144
    v_mfma_f32_32x32x16_bf16 v[24:39], a[108:111], a[236:239], v[24:39]
    v_rcp_f32 v145, v145
    v_rcp_f32 v146, v146
    v_rcp_f32 v147, v147
    s_waitcnt vmcnt(7)
    v_mfma_f32_32x32x16_bf16 v[8:23], a[24:27], a[240:243], v[8:23]
    buffer_load_dwordx4 a[232:235], v1, s[8:11], s14 offen offset:2048 sc1
    s_nop 0
    v_mul_f32 v64, v64, v140
    v_mul_f32 v65, v65, v141
    v_mul_f32 v66, v66, v142
    v_mfma_f32_32x32x16_bf16 v[24:39], a[112:115], a[240:243], v[24:39]
    v_mul_f32 v67, v67, v143
    v_mul_f32 v68, v68, v144
    v_mul_f32 v69, v69, v145
    v_mul_f32 v70, v70, v146
    v_mul_f32 v71, v71, v147
    s_waitcnt vmcnt(7)
    v_mfma_f32_32x32x16_bf16 v[8:23], a[28:31], a[244:247], v[8:23]
    buffer_load_dwordx4 a[236:239], v1, s[8:11], s14 offen offset:3072 sc1
    s_add_u32 s14, s14, 4096
    v_cvt_pk_bf16_f32 v148, v64, v65
    v_cvt_pk_bf16_f32 v149, v66, v67
    v_cvt_pk_bf16_f32 v150, v68, v69
    v_cvt_pk_bf16_f32 v151, v70, v71
    s_cmp_eq_u32 s94, 0
    s_cbranch_scc1 L_hs_45
    buffer_store_dwordx4 v[148:151], v1, s[8:11], s17 offen offset:0
    s_branch L_hs_45_e
L_hs_45:
    buffer_store_dwordx4 v[148:151], v1, s[8:11], s17 offen offset:0 sc1
L_hs_45_e:
    v_mfma_f32_32x32x16_bf16 v[24:39], a[116:119], a[244:247], v[24:39]
    v_mul_f32 v140, 0xbfb8aa3b, v72
    v_mul_f32 v141, 0xbfb8aa3b, v73
    v_mul_f32 v142, 0xbfb8aa3b, v74
    v_mul_f32 v143, 0xbfb8aa3b, v75
    v_mul_f32 v144, 0xbfb8aa3b, v76
    s_waitcnt vmcnt(8)
    v_mfma_f32_32x32x16_bf16 v[8:23], a[32:35], a[248:251], v[8:23]
    buffer_load_dwordx4 a[240:243], v1, s[8:11], s14 offen offset:0 sc1
    v_mul_f32 v145, 0xbfb8aa3b, v77
    v_mul_f32 v146, 0xbfb8aa3b, v78
    v_mul_f32 v147, 0xbfb8aa3b, v79
    v_exp_f32 v140, v140
    v_mfma_f32_32x32x16_bf16 v[24:39], a[120:123], a[248:251], v[24:39]
    v_exp_f32 v141, v141
    v_exp_f32 v142, v142
    v_exp_f32 v143, v143
    s_waitcnt vmcnt(8)
    v_mfma_f32_32x32x16_bf16 v[8:23], a[36:39], a[252:255], v[8:23]
    buffer_load_dwordx4 a[244:247], v1, s[8:11], s14 offen offset:1024 sc1
    v_exp_f32 v144, v144
    v_exp_f32 v145, v145
    v_mfma_f32_32x32x16_bf16 v[24:39], a[124:127], a[252:255], v[24:39]
    v_exp_f32 v146, v146
    v_exp_f32 v147, v147
    v_mul_f32 v80, v72, v80
    s_waitcnt vmcnt(8)
    v_mfma_f32_32x32x16_bf16 v[8:23], a[40:43], a[216:219], v[8:23]
    buffer_load_dwordx4 a[248:251], v1, s[8:11], s14 offen offset:2048 sc1
    v_mul_f32 v81, v73, v81
    v_mul_f32 v82, v74, v82
    v_mul_f32 v83, v75, v83
    v_mul_f32 v84, v76, v84
    v_mul_f32 v85, v77, v85
    v_mfma_f32_32x32x16_bf16 v[24:39], a[128:131], a[216:219], v[24:39]
    v_mul_f32 v86, v78, v86
    v_mul_f32 v87, v79, v87
    v_add_f32 v140, 1.0, v140
    v_add_f32 v141, 1.0, v141
    v_add_f32 v142, 1.0, v142
    s_waitcnt vmcnt(8)
    v_mfma_f32_32x32x16_bf16 v[8:23], a[44:47], a[220:223], v[8:23]
    buffer_load_dwordx4 a[252:255], v1, s[8:11], s14 offen offset:3072 sc1
    s_add_u32 s14, s14, 4096
    v_add_f32 v143, 1.0, v143
    v_add_f32 v144, 1.0, v144
    v_add_f32 v145, 1.0, v145
    v_add_f32 v146, 1.0, v146
    v_add_f32 v147, 1.0, v147
    v_mfma_f32_32x32x16_bf16 v[24:39], a[132:135], a[220:223], v[24:39]
    v_rcp_f32 v140, v140
    v_rcp_f32 v141, v141
    v_rcp_f32 v142, v142
    s_waitcnt vmcnt(8)
    v_mfma_f32_32x32x16_bf16 v[8:23], a[48:51], a[224:227], v[8:23]
    buffer_load_dwordx4 a[216:219], v1, s[8:11], s14 offen offset:0 sc1
    v_rcp_f32 v143, v143
    v_rcp_f32 v144, v144
    v_mfma_f32_32x32x16_bf16 v[24:39], a[136:139], a[224:227], v[24:39]
    v_rcp_f32 v145, v145
    v_rcp_f32 v146, v146
    v_rcp_f32 v147, v147
    s_waitcnt vmcnt(8)
    v_mfma_f32_32x32x16_bf16 v[8:23], a[52:55], a[228:231], v[8:23]
    buffer_load_dwordx4 a[220:223], v1, s[8:11], s18 offen sc1
    s_nop 0
    v_mul_f32 v80, v80, v140
    v_mul_f32 v81, v81, v141
    v_mul_f32 v82, v82, v142
    v_mfma_f32_32x32x16_bf16 v[24:39], a[140:143], a[228:231], v[24:39]
    v_mul_f32 v83, v83, v143
    v_mul_f32 v84, v84, v144
    v_mul_f32 v85, v85, v145
    v_mul_f32 v86, v86, v146
    v_mul_f32 v87, v87, v147
    s_waitcnt vmcnt(8)
    v_mfma_f32_32x32x16_bf16 v[8:23], a[56:59], a[232:235], v[8:23]
    v_cvt_pk_bf16_f32 v152, v80, v81
    v_cvt_pk_bf16_f32 v153, v82, v83
    v_cvt_pk_bf16_f32 v154, v84, v85
    v_cvt_pk_bf16_f32 v155, v86, v87
    s_cmp_eq_u32 s94, 0
    s_cbranch_scc1 L_hs_46
    buffer_store_dwordx4 v[152:155], v1, s[8:11], s17 offen offset:1024
    s_branch L_hs_46_e
L_hs_46:
    buffer_store_dwordx4 v[152:155], v1, s[8:11], s17 offen offset:1024 sc1
L_hs_46_e:
    v_mfma_f32_32x32x16_bf16 v[24:39], a[144:147], a[232:235], v[24:39]
    v_mul_f32 v140, 0xbfb8aa3b, v88
    v_mul_f32 v141, 0xbfb8aa3b, v89
    v_mul_f32 v142, 0xbfb8aa3b, v90
    v_mul_f32 v143, 0xbfb8aa3b, v91
    v_mul_f32 v144, 0xbfb8aa3b, v92
    s_waitcnt vmcnt(8)
    v_mfma_f32_32x32x16_bf16 v[8:23], a[60:63], a[236:239], v[8:23]
    v_mul_f32 v145, 0xbfb8aa3b, v93
    v_mul_f32 v146, 0xbfb8aa3b, v94
    v_mul_f32 v147, 0xbfb8aa3b, v95
    v_exp_f32 v140, v140
    v_mfma_f32_32x32x16_bf16 v[24:39], a[148:151], a[236:239], v[24:39]
    v_exp_f32 v141, v141
    v_exp_f32 v142, v142
    v_exp_f32 v143, v143
    s_waitcnt vmcnt(6)
    v_mfma_f32_32x32x16_bf16 v[8:23], a[64:67], a[240:243], v[8:23]
    v_exp_f32 v144, v144
    v_exp_f32 v145, v145
    v_mfma_f32_32x32x16_bf16 v[24:39], a[152:155], a[240:243], v[24:39]
    v_exp_f32 v146, v146
    v_exp_f32 v147, v147
    v_mul_f32 v96, v88, v96
    s_waitcnt vmcnt(5)
    v_mfma_f32_32x32x16_bf16 v[8:23], a[68:71], a[244:247], v[8:23]
    v_mul_f32 v97, v89, v97
    v_mul_f32 v98, v90, v98
    v_mul_f32 v99, v91, v99
    v_mul_f32 v100, v92, v100
    v_mul_f32 v101, v93, v101
    v_mfma_f32_32x32x16_bf16 v[24:39], a[156:159], a[244:247], v[24:39]
    v_mul_f32 v102, v94, v102
    v_mul_f32 v103, v95, v103
    v_add_f32 v140, 1.0, v140
    v_add_f32 v141, 1.0, v141
    v_add_f32 v142, 1.0, v142
    s_waitcnt vmcnt(4)
    v_mfma_f32_32x32x16_bf16 v[8:23], a[72:75], a[248:251], v[8:23]
    v_add_f32 v143, 1.0, v143
    v_add_f32 v144, 1.0, v144
    v_add_f32 v145, 1.0, v145
    v_add_f32 v146, 1.0, v146
    v_add_f32 v147, 1.0, v147
    v_mfma_f32_32x32x16_bf16 v[24:39], a[160:163], a[248:251], v[24:39]
    v_rcp_f32 v140, v140
    v_rcp_f32 v141, v141
    v_rcp_f32 v142, v142
    s_waitcnt vmcnt(3)
    v_mfma_f32_32x32x16_bf16 v[8:23], a[76:79], a[252:255], v[8:23]
    v_rcp_f32 v143, v143
    v_rcp_f32 v144, v144
    v_mfma_f32_32x32x16_bf16 v[24:39], a[164:167], a[252:255], v[24:39]
    v_rcp_f32 v145, v145
    v_rcp_f32 v146, v146
    v_rcp_f32 v147, v147
    s_waitcnt vmcnt(2)
    v_mfma_f32_32x32x16_bf16 v[8:23], a[80:83], a[216:219], v[8:23]
    s_nop 0
    v_mul_f32 v96, v96, v140
    v_mul_f32 v97, v97, v141
    v_mul_f32 v98, v98, v142
    v_mfma_f32_32x32x16_bf16 v[24:39], a[168:171], a[216:219], v[24:39]
    v_mul_f32 v99, v99, v143
    v_mul_f32 v100, v100, v144
    v_mul_f32 v101, v101, v145
    v_mul_f32 v102, v102, v146
    v_mul_f32 v103, v103, v147
    s_waitcnt vmcnt(1)
    v_mfma_f32_32x32x16_bf16 v[8:23], a[84:87], a[220:223], v[8:23]
    v_cvt_pk_bf16_f32 v156, v96, v97
    v_cvt_pk_bf16_f32 v157, v98, v99
    v_cvt_pk_bf16_f32 v158, v100, v101
    v_cvt_pk_bf16_f32 v159, v102, v103
    s_cmp_eq_u32 s94, 0
    s_cbranch_scc1 L_hs_47
    buffer_store_dwordx4 v[156:159], v1, s[8:11], s17 offen offset:2048
    s_branch L_hs_47_e
L_hs_47:
    buffer_store_dwordx4 v[156:159], v1, s[8:11], s17 offen offset:2048 sc1
L_hs_47_e:
    s_waitcnt vmcnt(0)
    v_mfma_f32_32x32x16_bf16 v[24:39], a[172:175], a[220:223], v[24:39]
    v_mov_b32 v214, 2
    v_mov_b32 v215, s27
    s_mov_b64 exec, 1
    s_cmp_eq_u32 s96, 0
    s_cbranch_scc1 L_hs_48
    buffer_store_byte v214, v215, s[8:11], 0 offen
    s_branch L_hs_48_e
L_hs_48:
    buffer_store_byte v214, v215, s[8:11], 0 offen sc1
L_hs_48_e:
    s_mov_b64 exec, -1
    s_waitcnt vmcnt(0) lgkmcnt(0)
    s_branch L_idle_33_j
L_idle_33:
    s_mul_i32 s39, s6, 22
    s_cmp_eq_u32 s6, 3
    s_subb_u32 s39, s39, 0
    s_and_b32 s36, s5, 7
    s_lshl_b32 s36, s36, 1
    s_add_u32 s36, s36, 0
    s_mul_i32 s36, s36, 86
    s_add_u32 s37, s36, 85
    s_add_u32 s36, s36, s39
    s_add_u32 s38, s36, 21
    s_min_u32 s38, s38, s37
    s_lshl_b32 s36, s36, 10
    s_add_u32 s36, s36, 29360128
    s_lshl_b32 s38, s38, 10
    s_add_u32 s38, s38, 29360128
    buffer_load_dwordx4 a[0:3], v1, s[8:11], s36 offen offset:0
    buffer_load_dwordx4 a[4:7], v1, s[8:11], s36 offen offset:1024
    buffer_load_dwordx4 a[8:11], v1, s[8:11], s36 offen offset:2048
    buffer_load_dwordx4 a[12:15], v1, s[8:11], s36 offen offset:3072
    s_add_u32 s36, s36, 4096
    buffer_load_dwordx4 a[16:19], v1, s[8:11], s36 offen offset:0
    buffer_load_dwordx4 a[20:23], v1, s[8:11], s36 offen offset:1024
    buffer_load_dwordx4 a[24:27], v1, s[8:11], s36 offen offset:2048
    buffer_load_dwordx4 a[28:31], v1, s[8:11], s36 offen offset:3072
    s_add_u32 s36, s36, 4096
    buffer_load_dwordx4 a[32:35], v1, s[8:11], s36 offen offset:0
    buffer_load_dwordx4 a[36:39], v1, s[8:11], s36 offen offset:1024
    buffer_load_dwordx4 a[40:43], v1, s[8:11], s36 offen offset:2048
    buffer_load_dwordx4 a[44:47], v1, s[8:11], s36 offen offset:3072
    s_add_u32 s36, s36, 4096
    buffer_load_dwordx4 a[48:51], v1, s[8:11], s36 offen offset:0
    buffer_load_dwordx4 a[52:55], v1, s[8:11], s36 offen offset:1024
    buffer_load_dwordx4 a[56:59], v1, s[8:11], s36 offen offset:2048
    buffer_load_dwordx4 a[60:63], v1, s[8:11], s36 offen offset:3072
    s_add_u32 s36, s36, 4096
    buffer_load_dwordx4 a[64:67], v1, s[8:11], s36 offen offset:0
    buffer_load_dwordx4 a[68:71], v1, s[8:11], s36 offen offset:1024
    buffer_load_dwordx4 a[72:75], v1, s[8:11], s36 offen offset:2048
    buffer_load_dwordx4 a[76:79], v1, s[8:11], s36 offen offset:3072
    s_add_u32 s36, s36, 4096
    buffer_load_dwordx4 a[80:83], v1, s[8:11], s36 offen offset:0
    buffer_load_dwordx4 a[84:87], v1, s[8:11], s38 offen
    s_and_b32 s36, s5, 7
    s_lshl_b32 s36, s36, 1
    s_add_u32 s36, s36, 1
    s_mul_i32 s36, s36, 86
    s_add_u32 s37, s36, 85
    s_add_u32 s36, s36, s39
    s_add_u32 s38, s36, 21
    s_min_u32 s38, s38, s37
    s_lshl_b32 s36, s36, 10
    s_add_u32 s36, s36, 29360128
    s_lshl_b32 s38, s38, 10
    s_add_u32 s38, s38, 29360128
    buffer_load_dwordx4 a[88:91], v1, s[8:11], s36 offen offset:0
    buffer_load_dwordx4 a[92:95], v1, s[8:11], s36 offen offset:1024
    buffer_load_dwordx4 a[96:99], v1, s[8:11], s36 offen offset:2048
    buffer_load_dwordx4 a[100:103], v1, s[8:11], s36 offen offset:3072
    s_add_u32 s36, s36, 4096
    buffer_load_dwordx4 a[104:107], v1, s[8:11], s36 offen offset:0
    buffer_load_dwordx4 a[108:111], v1, s[8:11], s36 offen offset:1024
    buffer_load_dwordx4 a[112:115], v1, s[8:11], s36 offen offset:2048
    buffer_load_dwordx4 a[116:119], v1, s[8:11], s36 offen offset:3072
    s_add_u32 s36, s36, 4096
    buffer_load_dwordx4 a[120:123], v1, s[8:11], s36 offen offset:0
    buffer_load_dwordx4 a[124:127], v1, s[8:11], s36 offen offset:1024
    buffer_load_dwordx4 a[128:131], v1, s[8:11], s36 offen offset:2048
    buffer_load_dwordx4 a[132:135], v1, s[8:11], s36 offen offset:3072
    s_add_u32 s36, s36, 4096
    buffer_load_dwordx4 a[136:139], v1, s[8:11], s36 offen offset:0
    buffer_load_dwordx4 a[140:143], v1, s[8:11], s36 offen offset:1024
    buffer_load_dwordx4 a[144:147], v1, s[8:11], s36 offen offset:2048
    buffer_load_dwordx4 a[148:151], v1, s[8:11], s36 offen offset:3072
    s_add_u32 s36, s36, 4096
    buffer_load_dwordx4 a[152:155], v1, s[8:11], s36 offen offset:0
    buffer_load_dwordx4 a[156:159], v1, s[8:11], s36 offen offset:1024
    buffer_load_dwordx4 a[160:163], v1, s[8:11], s36 offen offset:2048
    buffer_load_dwordx4 a[164:167], v1, s[8:11], s36 offen offset:3072
    s_add_u32 s36, s36, 4096
    buffer_load_dwordx4 a[168:171], v1, s[8:11], s36 offen offset:0
    buffer_load_dwordx4 a[172:175], v1, s[8:11], s38 offen
    s_mul_i32 s28, s6, 7
    s_lshr_b32 s29, s5, 3
    s_lshl_b32 s29, s29, 3
    s_lshl_b32 s29, 0x80, s29
    s_lshl_b32 s28, s28, 2
    s_add_u32 s28, s28, s24
    v_and_b32 v211, 7, v0
    v_lshlrev_b32 v211, 2, v211
    v_add_u32 v211, s28, v211
    s_mov_b32 s30, 2122219134
    buffer_load_dword v210, v211, s[8:11], 0 offen sc1
    s_waitcnt vmcnt(0)
    v_add_u32 v210, s30, v210
    v_and_b32 v210, s29, v210
    v_cmp_eq_u32 vcc, s29, v210
    s_cmp_eq_u64 vcc, -1
    s_cbranch_scc1 L_cf_49_d
    s_mov_b32 s98, 0
L_cf_49:
    buffer_load_dword v210, v211, s[8:11], 0 offen sc1
    s_waitcnt vmcnt(0)
    v_add_u32 v210, s30, v210
    v_and_b32 v210, s29, v210
    v_cmp_eq_u32 vcc, s29, v210
    s_add_u32 s98, s98, 1
    s_cmp_eq_u64 vcc, -1
    s_cbranch_scc1 L_cf_49_d
    s_cmp_lt_u32 s98, 0x8000
    s_cbranch_scc1 L_cf_49
L_cf_49_d:
    buffer_load_dwordx4 a[216:219], v1, s[8:11], s14 offen offset:0 sc1
    buffer_load_dwordx4 a[220:223], v1, s[8:11], s14 offen offset:1024 sc1
    buffer_load_dwordx4 a[224:227], v1, s[8:11], s14 offen offset:2048 sc1
    buffer_load_dwordx4 a[228:231], v1, s[8:11], s14 offen offset:3072 sc1
    s_add_u32 s14, s14, 4096
    buffer_load_dwordx4 a[232:235], v1, s[8:11], s14 offen offset:0 sc1
    buffer_load_dwordx4 a[236:239], v1, s[8:11], s14 offen offset:1024 sc1
    buffer_load_dwordx4 a[240:243], v1, s[8:11], s14 offen offset:2048 sc1
    buffer_load_dwordx4 a[244:247], v1, s[8:11], s14 offen offset:3072 sc1
    s_add_u32 s14, s14, 4096
    s_waitcnt vmcnt(7)
    v_mfma_f32_32x32x16_bf16 v[8:23], a[0:3], a[216:219], 0
    buffer_load_dwordx4 a[248:251], v1, s[8:11], s14 offen offset:0 sc1
    v_mfma_f32_32x32x16_bf16 v[24:39], a[88:91], a[216:219], 0
    s_waitcnt vmcnt(7)
    v_mfma_f32_32x32x16_bf16 v[8:23], a[4:7], a[220:223], v[8:23]
    buffer_load_dwordx4 a[252:255], v1, s[8:11], s14 offen offset:1024 sc1
    v_mfma_f32_32x32x16_bf16 v[24:39], a[92:95], a[220:223], v[24:39]
    s_waitcnt vmcnt(7)
    v_mfma_f32_32x32x16_bf16 v[8:23], a[8:11], a[224:227], v[8:23]
    buffer_load_dwordx4 a[216:219], v1, s[8:11], s14 offen offset:2048 sc1
    v_mfma_f32_32x32x16_bf16 v[24:39], a[96:99], a[224:227], v[24:39]
    s_waitcnt vmcnt(7)
    v_mfma_f32_32x32x16_bf16 v[8:23], a[12:15], a[228:231], v[8:23]
    buffer_load_dwordx4 a[220:223], v1, s[8:11], s14 offen offset:3072 sc1
    s_add_u32 s14, s14, 4096
    v_mfma_f32_32x32x16_bf16 v[24:39], a[100:103], a[228:231], v[24:39]
    s_waitcnt vmcnt(7)
    v_mfma_f32_32x32x16_bf16 v[8:23], a[16:19], a[232:235], v[8:23]
    buffer_load_dwordx4 a[224:227], v1, s[8:11], s14 offen offset:0 sc1
    v_mfma_f32_32x32x16_bf16 v[24:39], a[104:107], a[232:235], v[24:39]
    s_waitcnt vmcnt(7)
    v_mfma_f32_32x32x16_bf16 v[8:23], a[20:23], a[236:239], v[8:23]
    buffer_load_dwordx4 a[228:231], v1, s[8:11], s14 offen offset:1024 sc1
    v_mfma_f32_32x32x16_bf16 v[24:39], a[108:111], a[236:239], v[24:39]
    s_waitcnt vmcnt(7)
    v_mfma_f32_32x32x16_bf16 v[8:23], a[24:27], a[240:243], v[8:23]
    buffer_load_dwordx4 a[232:235], v1, s[8:11], s14 offen offset:2048 sc1
    v_mfma_f32_32x32x16_bf16 v[24:39], a[112:115], a[240:243], v[24:39]
    s_waitcnt vmcnt(7)
    v_mfma_f32_32x32x16_bf16 v[8:23], a[28:31], a[244:247], v[8:23]
    buffer_load_dwordx4 a[236:239], v1, s[8:11], s14 offen offset:3072 sc1
    s_add_u32 s14, s14, 4096
    v_mfma_f32_32x32x16_bf16 v[24:39], a[116:119], a[244:247], v[24:39]
    s_waitcnt vmcnt(7)
    v_mfma_f32_32x32x16_bf16 v[8:23], a[32:35], a[248:251], v[8:23]
    buffer_load_dwordx4 a[240:243], v1, s[8:11], s14 offen offset:0 sc1
    v_mfma_f32_32x32x16_bf16 v[24:39], a[120:123], a[248:251], v[24:39]
    s_waitcnt vmcnt(7)
    v_mfma_f32_32x32x16_bf16 v[8:23], a[36:39], a[252:255], v[8:23]
    buffer_load_dwordx4 a[244:247], v1, s[8:11], s14 offen offset:1024 sc1
    v_mfma_f32_32x32x16_bf16 v[24:39], a[124:127], a[252:255], v[24:39]
    s_waitcnt vmcnt(7)
    v_mfma_f32_32x32x16_bf16 v[8:23], a[40:43], a[216:219], v[8:23]
    buffer_load_dwordx4 a[248:251], v1, s[8:11], s14 offen offset:2048 sc1
    v_mfma_f32_32x32x16_bf16 v[24:39], a[128:131], a[216:219], v[24:39]
    s_waitcnt vmcnt(7)
    v_mfma_f32_32x32x16_bf16 v[8:23], a[44:47], a[220:223], v[8:23]
    buffer_load_dwordx4 a[252:255], v1, s[8:11], s14 offen offset:3072 sc1
    s_add_u32 s14, s14, 4096
    v_mfma_f32_32x32x16_bf16 v[24:39], a[132:135], a[220:223], v[24:39]
    s_waitcnt vmcnt(7)
    v_mfma_f32_32x32x16_bf16 v[8:23], a[48:51], a[224:227], v[8:23]
    buffer_load_dwordx4 a[216:219], v1, s[8:11], s14 offen offset:0 sc1
    v_mfma_f32_32x32x16_bf16 v[24:39], a[136:139], a[224:227], v[24:39]
    s_waitcnt vmcnt(7)
    v_mfma_f32_32x32x16_bf16 v[8:23], a[52:55], a[228:231], v[8:23]
    buffer_load_dwordx4 a[220:223], v1, s[8:11], s18 offen sc1
    v_mfma_f32_32x32x16_bf16 v[24:39], a[140:143], a[228:231], v[24:39]
    s_waitcnt vmcnt(7)
    v_mfma_f32_32x32x16_bf16 v[8:23], a[56:59], a[232:235], v[8:23]
    v_mfma_f32_32x32x16_bf16 v[24:39], a[144:147], a[232:235], v[24:39]
    s_waitcnt vmcnt(6)
    v_mfma_f32_32x32x16_bf16 v[8:23], a[60:63], a[236:239], v[8:23]
    v_mfma_f32_32x32x16_bf16 v[24:39], a[148:151], a[236:239], v[24:39]
    s_waitcnt vmcnt(5)
    v_mfma_f32_32x32x16_bf16 v[8:23], a[64:67], a[240:243], v[8:23]
    v_mfma_f32_32x32x16_bf16 v[24:39], a[152:155], a[240:243], v[24:39]
    s_waitcnt vmcnt(4)
    v_mfma_f32_32x32x16_bf16 v[8:23], a[68:71], a[244:247], v[8:23]
    v_mfma_f32_32x32x16_bf16 v[24:39], a[156:159], a[244:247], v[24:39]
    s_waitcnt vmcnt(3)
    v_mfma_f32_32x32x16_bf16 v[8:23], a[72:75], a[248:251], v[8:23]
    v_mfma_f32_32x32x16_bf16 v[24:39], a[160:163], a[248:251], v[24:39]
    s_waitcnt vmcnt(2)
    v_mfma_f32_32x32x16_bf16 v[8:23], a[76:79], a[252:255], v[8:23]
    v_mfma_f32_32x32x16_bf16 v[24:39], a[164:167], a[252:255], v[24:39]
    s_waitcnt vmcnt(1)
    v_mfma_f32_32x32x16_bf16 v[8:23], a[80:83], a[216:219], v[8:23]
    v_mfma_f32_32x32x16_bf16 v[24:39], a[168:171], a[216:219], v[24:39]
    s_waitcnt vmcnt(0)
    v_mfma_f32_32x32x16_bf16 v[8:23], a[84:87], a[220:223], v[8:23]
    v_mfma_f32_32x32x16_bf16 v[24:39], a[172:175], a[220:223], v[24:39]
    s_waitcnt vmcnt(0) lgkmcnt(0)
L_idle_33_j:
    s_lshl_b32 s62, s6, 11
    s_add_u32 s62, s62, 0
    v_add_u32 v200, s62, v1
    s_nop 5
    s_nop 5
    s_cmp_eq_u32 s6, 0
    s_cbranch_scc1 L_own_51
    ds_write_b128 v200, v[8:11] offset:0
    ds_write_b128 v200, v[12:15] offset:1024
    s_branch L_own_51_n
L_own_51:
    v_mov_b32 v160, v8
    v_mov_b32 v161, v9
    v_mov_b32 v162, v10
    v_mov_b32 v163, v11
    v_mov_b32 v164, v12
    v_mov_b32 v165, v13
    v_mov_b32 v166, v14
    v_mov_b32 v167, v15
L_own_51_n:
    s_cmp_eq_u32 s6, 1
    s_cbranch_scc1 L_own_52
    ds_write_b128 v200, v[16:19] offset:8192
    ds_write_b128 v200, v[20:23] offset:9216
    s_branch L_own_52_n
L_own_52:
    v_mov_b32 v160, v16
    v_mov_b32 v161, v17
    v_mov_b32 v162, v18
    v_mov_b32 v163, v19
    v_mov_b32 v164, v20
    v_mov_b32 v165, v21
    v_mov_b32 v166, v22
    v_mov_b32 v167, v23
L_own_52_n:
    s_cmp_eq_u32 s6, 2
    s_cbranch_scc1 L_own_53
    ds_write_b128 v200, v[24:27] offset:16384
    ds_write_b128 v200, v[28:31] offset:17408
    s_branch L_own_53_n
L_own_53:
    v_mov_b32 v160, v24
    v_mov_b32 v161, v25
    v_mov_b32 v162, v26
    v_mov_b32 v163, v27
    v_mov_b32 v164, v28
    v_mov_b32 v165, v29
    v_mov_b32 v166, v30
    v_mov_b32 v167, v31
L_own_53_n:
    s_cmp_eq_u32 s6, 3
    s_cbranch_scc1 L_own_54
    ds_write_b128 v200, v[32:35] offset:24576
    ds_write_b128 v200, v[36:39] offset:25600
    s_branch L_own_54_n
L_own_54:
    v_mov_b32 v160, v32
    v_mov_b32 v161, v33
    v_mov_b32 v162, v34
    v_mov_b32 v163, v35
    v_mov_b32 v164, v36
    v_mov_b32 v165, v37
    v_mov_b32 v166, v38
    v_mov_b32 v167, v39
L_own_54_n:
    s_waitcnt lgkmcnt(0)
    s_waitcnt lgkmcnt(0)
    v_mov_b32 v202, 64896
    v_mov_b32 v203, 1
    s_add_u32 s22, s22, 4
    s_mov_b64 exec, 1
    ds_add_u32 v202, v203
    s_mov_b64 exec, -1
    s_mov_b32 s98, 0
L_s4_55:
    ds_read_b32 v203, v202
    s_waitcnt lgkmcnt(0)
    v_readfirstlane_b32 s61, v203
    s_add_u32 s98, s98, 1
    s_cmp_ge_u32 s61, s22
    s_cbranch_scc1 L_s4_55_d
    s_cmp_lt_u32 s98, 0x100000
    s_cbranch_scc1 L_s4_55
L_s4_55_d:
    s_mul_i32 s28, s6, 7
    s_lshr_b32 s29, s5, 3
    s_lshl_b32 s29, s29, 3
    s_lshl_b32 s29, 0x80, s29
    s_lshl_b32 s28, s28, 2
    s_add_u32 s28, s28, s25
    v_and_b32 v211, 7, v0
    v_lshlrev_b32 v211, 2, v211
    v_add_u32 v211, s28, v211
    s_mov_b32 s30, 2122219134
    buffer_load_dword v210, v211, s[8:11], 0 offen sc1
    s_lshl_b32 s62, s6, 13
    s_add_u32 s62, s62, 0
    s_add_u32 s63, s6, 1
    s_and_b32 s63, s63, 3
    s_lshl_b32 s63, s63, 11
    s_add_u32 s63, s63, s62
    v_add_u32 v200, s63, v1
    ds_read_b128 v[168:171], v200
    ds_read_b128 v[172:175], v200 offset:1024
    s_add_u32 s63, s6, 2
    s_and_b32 s63, s63, 3
    s_lshl_b32 s63, s63, 11
    s_add_u32 s63, s63, s62
    v_add_u32 v200, s63, v1
    ds_read_b128 v[176:179], v200
    ds_read_b128 v[180:183], v200 offset:1024
    s_add_u32 s63, s6, 3
    s_and_b32 s63, s63, 3
    s_lshl_b32 s63, s63, 11
    s_add_u32 s63, s63, s62
    v_add_u32 v200, s63, v1
    ds_read_b128 v[184:187], v200
    ds_read_b128 v[188:191], v200 offset:1024
    s_waitcnt lgkmcnt(0)
    v_add_f32 v160, v160, v168
    v_add_f32 v161, v161, v169
    v_add_f32 v162, v162, v170
    v_add_f32 v163, v163, v171
    v_add_f32 v164, v164, v172
    v_add_f32 v165, v165, v173
    v_add_f32 v166, v166, v174
    v_add_f32 v167, v167, v175
    v_add_f32 v176, v176, v184
    v_add_f32 v177, v177, v185
    v_add_f32 v178, v178, v186
    v_add_f32 v179, v179, v187
    v_add_f32 v180, v180, v188
    v_add_f32 v181, v181, v189
    v_add_f32 v182, v182, v190
    v_add_f32 v183, v183, v191
    v_add_f32 v160, v160, v176
    v_add_f32 v161, v161, v177
    v_add_f32 v162, v162, v178
    v_add_f32 v163, v163, v179
    v_add_f32 v164, v164, v180
    v_add_f32 v165, v165, v181
    v_add_f32 v166, v166, v182
    v_add_f32 v167, v167, v183
    v_cvt_pk_bf16_f32 v192, v160, v161
    v_cvt_pk_bf16_f32 v193, v162, v163
    v_cvt_pk_bf16_f32 v194, v164, v165
    v_cvt_pk_bf16_f32 v195, v166, v167
    s_nop 1
    v_permlane32_swap_b32 v192, v194
    v_permlane32_swap_b32 v193, v195
    s_add_u32 s63, s20, 9437184
    buffer_store_dwordx4 v[192:195], v5, s[8:11], s63 offen sc1
    s_waitcnt vmcnt(1)
    v_add_u32 v210, s30, v210
    v_and_b32 v210, s29, v210
    v_cmp_eq_u32 vcc, s29, v210
    s_cmp_eq_u64 vcc, -1
    s_cbranch_scc1 L_cf_57_d
    s_mov_b32 s98, 0
L_cf_57:
    buffer_load_dword v210, v211, s[8:11], 0 offen sc1
    s_waitcnt vmcnt(0)
    v_add_u32 v210, s30, v210
    v_and_b32 v210, s29, v210
    v_cmp_eq_u32 vcc, s29, v210
    s_add_u32 s98, s98, 1
    s_cmp_eq_u64 vcc, -1
    s_cbranch_scc1 L_cf_57_d
    s_cmp_lt_u32 s98, 0x8000
    s_cbranch_scc1 L_cf_57
L_cf_57_d:
    buffer_load_dwordx4 a[224:227], v1, s[8:11], s15 offen offset:0 sc1
    buffer_load_dwordx4 a[228:231], v1, s[8:11], s15 offen offset:1024 sc1
    buffer_load_dwordx4 a[232:235], v1, s[8:11], s15 offen offset:2048 sc1
    buffer_load_dwordx4 a[236:239], v1, s[8:11], s15 offen offset:3072 sc1
    s_add_u32 s15, s15, 4096
    buffer_load_dwordx4 a[240:243], v1, s[8:11], s15 offen offset:0 sc1
    buffer_load_dwordx4 a[244:247], v1, s[8:11], s15 offen offset:1024 sc1
    buffer_load_dwordx4 a[248:251], v1, s[8:11], s15 offen offset:2048 sc1
    buffer_load_dwordx4 a[252:255], v1, s[8:11], s15 offen offset:3072 sc1
    s_add_u32 s15, s15, 4096
    s_waitcnt vmcnt(7)
    v_mfma_f32_32x32x16_bf16 v[56:71], a[0:3], a[224:227], 0
    buffer_load_dwordx4 a[216:219], v1, s[8:11], s15 offen offset:0 sc1
    v_mfma_f32_32x32x16_bf16 v[72:87], a[88:91], a[224:227], 0
    s_waitcnt vmcnt(7)
    v_mfma_f32_32x32x16_bf16 v[56:71], a[4:7], a[228:231], v[56:71]
    buffer_load_dwordx4 a[220:223], v1, s[8:11], s15 offen offset:1024 sc1
    v_mfma_f32_32x32x16_bf16 v[72:87], a[92:95], a[228:231], v[72:87]
    s_waitcnt vmcnt(7)
    v_mfma_f32_32x32x16_bf16 v[56:71], a[8:11], a[232:235], v[56:71]
    buffer_load_dwordx4 a[224:227], v1, s[8:11], s15 offen offset:2048 sc1
    v_mfma_f32_32x32x16_bf16 v[72:87], a[96:99], a[232:235], v[72:87]
    s_waitcnt vmcnt(7)
    v_mfma_f32_32x32x16_bf16 v[56:71], a[12:15], a[236:239], v[56:71]
    buffer_load_dwordx4 a[228:231], v1, s[8:11], s15 offen offset:3072 sc1
    s_add_u32 s15, s15, 4096
    v_mfma_f32_32x32x16_bf16 v[72:87], a[100:103], a[236:239], v[72:87]
    v_mov_b32 v214, 3
    v_mov_b32 v215, s26
    s_mov_b64 exec, 1
    s_cmp_eq_u32 s96, 0
    s_cbranch_scc1 L_hs_56
    buffer_store_byte v214, v215, s[8:11], 0 offen
    s_branch L_hs_56_e
L_hs_56:
    buffer_store_byte v214, v215, s[8:11], 0 offen sc1
L_hs_56_e:
    s_mov_b64 exec, -1
    s_waitcnt vmcnt(8)
    v_mfma_f32_32x32x16_bf16 v[56:71], a[16:19], a[240:243], v[56:71]
    buffer_load_dwordx4 a[232:235], v1, s[8:11], s15 offen offset:0 sc1
    v_mfma_f32_32x32x16_bf16 v[72:87], a[104:107], a[240:243], v[72:87]
    s_waitcnt vmcnt(8)
    v_mfma_f32_32x32x16_bf16 v[56:71], a[20:23], a[244:247], v[56:71]
    buffer_load_dwordx4 a[236:239], v1, s[8:11], s15 offen offset:1024 sc1
    v_mfma_f32_32x32x16_bf16 v[72:87], a[108:111], a[244:247], v[72:87]
    s_waitcnt vmcnt(8)
    v_mfma_f32_32x32x16_bf16 v[56:71], a[24:27], a[248:251], v[56:71]
    buffer_load_dwordx4 a[240:243], v1, s[8:11], s15 offen offset:2048 sc1
    v_mfma_f32_32x32x16_bf16 v[72:87], a[112:115], a[248:251], v[72:87]
    s_waitcnt vmcnt(8)
    v_mfma_f32_32x32x16_bf16 v[56:71], a[28:31], a[252:255], v[56:71]
    buffer_load_dwordx4 a[244:247], v1, s[8:11], s15 offen offset:3072 sc1
    s_add_u32 s15, s15, 4096
    v_mfma_f32_32x32x16_bf16 v[72:87], a[116:119], a[252:255], v[72:87]
    s_waitcnt vmcnt(8)
    v_mfma_f32_32x32x16_bf16 v[56:71], a[32:35], a[216:219], v[56:71]
    buffer_load_dwordx4 a[248:251], v1, s[8:11], s15 offen offset:0 sc1
    v_mfma_f32_32x32x16_bf16 v[72:87], a[120:123], a[216:219], v[72:87]
    s_waitcnt vmcnt(8)
    v_mfma_f32_32x32x16_bf16 v[56:71], a[36:39], a[220:223], v[56:71]
    buffer_load_dwordx4 a[252:255], v1, s[8:11], s15 offen offset:1024 sc1
    v_mfma_f32_32x32x16_bf16 v[72:87], a[124:127], a[220:223], v[72:87]
    s_and_b32 s28, s5, 24
    s_mov_b32 s29, 0x80808080
    s_lshl_b32 s28, s28, 2
    s_add_u32 s28, s28, s24
    v_and_b32 v211, 7, v0
    v_lshlrev_b32 v211, 2, v211
    v_add_u32 v211, s28, v211
    s_mov_b32 s30, 2105376125
    buffer_load_dword v210, v211, s[8:11], 0 offen sc1
    s_waitcnt vmcnt(9)
    v_mfma_f32_32x32x16_bf16 v[56:71], a[40:43], a[224:227], v[56:71]
    buffer_load_dwordx4 a[216:219], v1, s[8:11], s15 offen offset:2048 sc1
    v_mfma_f32_32x32x16_bf16 v[72:87], a[128:131], a[224:227], v[72:87]
    s_waitcnt vmcnt(9)
    v_mfma_f32_32x32x16_bf16 v[56:71], a[44:47], a[228:231], v[56:71]
    buffer_load_dwordx4 a[220:223], v1, s[8:11], s15 offen offset:3072 sc1
    s_add_u32 s15, s15, 4096
    v_mfma_f32_32x32x16_bf16 v[72:87], a[132:135], a[228:231], v[72:87]
    s_waitcnt vmcnt(8)
    v_mfma_f32_32x32x16_bf16 v[56:71], a[48:51], a[232:235], v[56:71]
    buffer_load_dwordx4 a[224:227], v1, s[8:11], s15 offen offset:0 sc1
    v_mfma_f32_32x32x16_bf16 v[72:87], a[136:139], a[232:235], v[72:87]
    s_waitcnt vmcnt(8)
    v_mfma_f32_32x32x16_bf16 v[56:71], a[52:55], a[236:239], v[56:71]
    buffer_load_dwordx4 a[228:231], v1, s[8:11], s19 offen sc1
    v_mfma_f32_32x32x16_bf16 v[72:87], a[140:143], a[236:239], v[72:87]
    s_waitcnt vmcnt(4)
    v_add_u32 v210, s30, v210
    v_and_b32 v210, s29, v210
    v_cmp_eq_u32 vcc, s29, v210
    s_cmp_eq_u64 vcc, -1
    s_cbranch_scc1 L_cf_58_d
    s_mov_b32 s98, 0
L_cf_58:
    buffer_load_dword v210, v211, s[8:11], 0 offen sc1
    s_waitcnt vmcnt(0)
    v_add_u32 v210, s30, v210
    v_and_b32 v210, s29, v210
    v_cmp_eq_u32 vcc, s29, v210
    s_add_u32 s98, s98, 1
    s_cmp_eq_u64 vcc, -1
    s_cbranch_scc1 L_cf_58_d
    s_cmp_lt_u32 s98, 0x8000
    s_cbranch_scc1 L_cf_58
L_cf_58_d:
    v_mfma_f32_32x32x16_bf16 v[56:71], a[56:59], a[240:243], v[56:71]
    s_lshl_b32 s41, s4, 3
    s_lshr_b32 s40, s5, 3
    s_add_u32 s41, s41, s40
    s_add_u32 s41, s41, 0
    s_lshl_b32 s41, s41, 15
    s_and_b32 s40, s5, 7
    s_lshl_b32 s40, s40, 2
    v_mfma_f32_32x32x16_bf16 v[72:87], a[144:147], a[240:243], v[72:87]
    s_add_u32 s40, s40, s6
    s_lshl_b32 s40, s40, 5
    s_add_u32 s41, s41, s40
    s_add_u32 s41, s41, 9437184
    buffer_load_dwordx4 v[136:139], v7, s[8:11], s41 offen sc1
    v_lshlrev_b32 v104, 16, v240
    v_and_b32 v105, 0xffff0000, v240
    v_lshlrev_b32 v106, 16, v241
    v_mfma_f32_32x32x16_bf16 v[56:71], a[60:63], a[244:247], v[56:71]
    v_and_b32 v107, 0xffff0000, v241
    v_lshlrev_b32 v108, 16, v242
    v_and_b32 v109, 0xffff0000, v242
    v_lshlrev_b32 v110, 16, v243
    v_and_b32 v111, 0xffff0000, v243
    v_mfma_f32_32x32x16_bf16 v[72:87], a[148:151], a[244:247], v[72:87]
    v_mfma_f32_32x32x16_bf16 v[56:71], a[64:67], a[248:251], v[56:71]
    v_mfma_f32_32x32x16_bf16 v[72:87], a[152:155], a[248:251], v[72:87]
    v_mfma_f32_32x32x16_bf16 v[56:71], a[68:71], a[252:255], v[56:71]
    v_mfma_f32_32x32x16_bf16 v[72:87], a[156:159], a[252:255], v[72:87]
    s_waitcnt vmcnt(4)
    v_mfma_f32_32x32x16_bf16 v[56:71], a[72:75], a[216:219], v[56:71]
    v_mfma_f32_32x32x16_bf16 v[72:87], a[160:163], a[216:219], v[72:87]
    s_waitcnt vmcnt(3)
    v_mfma_f32_32x32x16_bf16 v[56:71], a[76:79], a[220:223], v[56:71]
    s_waitcnt vmcnt(0)
    v_lshlrev_b32 v120, 16, v136
    v_and_b32 v121, 0xffff0000, v136
    v_mfma_f32_32x32x16_bf16 v[72:87], a[164:167], a[220:223], v[72:87]
    v_lshlrev_b32 v122, 16, v137
    v_and_b32 v123, 0xffff0000, v137
    v_lshlrev_b32 v124, 16, v138
    v_and_b32 v125, 0xffff0000, v138
    v_lshlrev_b32 v126, 16, v139
    v_and_b32 v127, 0xffff0000, v139
    v_add_f32 v104, v104, v120
    v_mfma_f32_32x32x16_bf16 v[56:71], a[80:83], a[224:227], v[56:71]
    v_add_f32 v105, v105, v121
    v_add_f32 v106, v106, v122
    v_add_f32 v107, v107, v123
    v_add_f32 v108, v108, v124
    v_add_f32 v109, v109, v125
    v_add_f32 v110, v110, v126
    v_add_f32 v111, v111, v127
    v_cvt_pk_bf16_f32 v136, v104, v105
    v_mfma_f32_32x32x16_bf16 v[72:87], a[168:171], a[224:227], v[72:87]
    v_cvt_pk_bf16_f32 v137, v106, v107
    v_cvt_pk_bf16_f32 v138, v108, v109
    v_cvt_pk_bf16_f32 v139, v110, v111
    v_lshlrev_b32 v104, 16, v136
    v_and_b32 v105, 0xffff0000, v136
    v_lshlrev_b32 v106, 16, v137
    v_and_b32 v107, 0xffff0000, v137
    v_mfma_f32_32x32x16_bf16 v[56:71], a[84:87], a[228:231], v[56:71]
    v_lshlrev_b32 v108, 16, v138
    v_and_b32 v109, 0xffff0000, v138
    v_lshlrev_b32 v110, 16, v139
    v_and_b32 v111, 0xffff0000, v139
    v_add_f32 v128, v104, v105
    v_mul_f32 v129, v104, v104
    v_add_f32 v130, v106, v107
    v_mul_f32 v131, v105, v105
    v_mfma_f32_32x32x16_bf16 v[72:87], a[172:175], a[228:231], v[72:87]
    v_add_f32 v132, v108, v109
    v_fmac_f32 v129, v106, v106
    v_add_f32 v133, v110, v111
    v_fmac_f32 v131, v107, v107
    v_add_f32 v128, v128, v130
    v_fmac_f32 v129, v108, v108
    v_add_f32 v132, v132, v133
    s_mov_b32 s94, s96
    s_lshl_b32 s62, s6, 11
    v_fmac_f32 v131, v109, v109
    s_add_u32 s62, s62, 32768
    v_fmac_f32 v129, v110, v110
    v_add_u32 v200, s62, v1
    v_fmac_f32 v131, v111, v111
    s_nop 5
    v_add_f32 v128, v128, v132
    s_nop 5
    v_add_f32 v129, v129, v131
    s_cmp_eq_u32 s6, 0
    s_cbranch_scc1 L_own_63
    ds_write_b128 v200, v[56:59] offset:0
    ds_write_b128 v200, v[60:63] offset:1024
    s_branch L_own_63_n
L_own_63:
    v_mov_b32 v160, v56
    v_mov_b32 v161, v57
    v_mov_b32 v162, v58
    v_mov_b32 v163, v59
    v_mov_b32 v164, v60
    v_mov_b32 v165, v61
    v_mov_b32 v166, v62
    v_mov_b32 v167, v63
L_own_63_n:
    s_nop 0
    s_cmp_eq_u32 s6, 1
    s_cbranch_scc1 L_own_64
    ds_write_b128 v200, v[64:67] offset:8192
    ds_write_b128 v200, v[68:71] offset:9216
    s_branch L_own_64_n
L_own_64:
    v_mov_b32 v160, v64
    v_mov_b32 v161, v65
    v_mov_b32 v162, v66
    v_mov_b32 v163, v67
    v_mov_b32 v164, v68
    v_mov_b32 v165, v69
    v_mov_b32 v166, v70
    v_mov_b32 v167, v71
L_own_64_n:
    v_add_f32_dpp v128, v128, v128 row_shr:1 row_mask:0xf bank_mask:0xf bound_ctrl:0
    s_cmp_eq_u32 s6, 2
    s_cbranch_scc1 L_own_65
    ds_write_b128 v200, v[72:75] offset:16384
    ds_write_b128 v200, v[76:79] offset:17408
    s_branch L_own_65_n
L_own_65:
    v_mov_b32 v160, v72
    v_mov_b32 v161, v73
    v_mov_b32 v162, v74
    v_mov_b32 v163, v75
    v_mov_b32 v164, v76
    v_mov_b32 v165, v77
    v_mov_b32 v166, v78
    v_mov_b32 v167, v79
L_own_65_n:
    v_add_f32_dpp v129, v129, v129 row_shr:1 row_mask:0xf bank_mask:0xf bound_ctrl:0
    s_cmp_eq_u32 s6, 3
    s_cbranch_scc1 L_own_66
    ds_write_b128 v200, v[80:83] offset:24576
    ds_write_b128 v200, v[84:87] offset:25600
    s_branch L_own_66_n
L_own_66:
    v_mov_b32 v160, v80
    v_mov_b32 v161, v81
    v_mov_b32 v162, v82
    v_mov_b32 v163, v83
    v_mov_b32 v164, v84
    v_mov_b32 v165, v85
    v_mov_b32 v166, v86
    v_mov_b32 v167, v87
L_own_66_n:
    s_nop 0
    s_waitcnt lgkmcnt(0)
    v_add_f32_dpp v128, v128, v128 row_shr:2 row_mask:0xf bank_mask:0xf bound_ctrl:0
    s_waitcnt lgkmcnt(0)
    v_add_f32_dpp v129, v129, v129 row_shr:2 row_mask:0xf bank_mask:0xf bound_ctrl:0
    v_mov_b32 v202, 64912
    v_mov_b32 v203, 1
    s_add_u32 s23, s23, 4
    s_mov_b64 exec, 1
    ds_add_u32 v202, v203
    s_mov_b64 exec, -1
    s_mov_b32 s98, 0
L_s4_67:
    ds_read_b32 v203, v202
    s_waitcnt lgkmcnt(0)
    v_readfirstlane_b32 s61, v203
    s_add_u32 s98, s98, 1
    s_cmp_ge_u32 s61, s23
    s_cbranch_scc1 L_s4_67_d
    s_cmp_lt_u32 s98, 0x100000
    s_cbranch_scc1 L_s4_67
L_s4_67_d:
    s_nop 0
    s_lshl_b32 s62, s6, 13
    v_add_f32_dpp v128, v128, v128 row_shr:4 row_mask:0xf bank_mask:0xf bound_ctrl:0
    s_add_u32 s62, s62, 32768
    v_add_f32_dpp v129, v129, v129 row_shr:4 row_mask:0xf bank_mask:0xf bound_ctrl:0
    s_add_u32 s63, s6, 1
    s_nop 0
    s_and_b32 s63, s63, 3
    v_add_f32_dpp v128, v128, v128 row_shr:8 row_mask:0xf bank_mask:0xf bound_ctrl:0
    s_lshl_b32 s63, s63, 11
    v_add_f32_dpp v129, v129, v129 row_shr:8 row_mask:0xf bank_mask:0xf bound_ctrl:0
    s_add_u32 s63, s63, s62
    s_nop 0
    v_add_u32 v200, s63, v1
    v_add_f32_dpp v128, v128, v128 row_bcast:15 row_mask:0xa bank_mask:0xf
    ds_read_b128 v[168:171], v200
    v_add_f32_dpp v129, v129, v129 row_bcast:15 row_mask:0xa bank_mask:0xf
    ds_read_b128 v[172:175], v200 offset:1024
    s_nop 0
    s_add_u32 s63, s6, 2
    v_add_f32_dpp v128, v128, v128 row_bcast:31 row_mask:0xc bank_mask:0xf
    s_and_b32 s63, s63, 3
    v_add_f32_dpp v129, v129, v129 row_bcast:31 row_mask:0xc bank_mask:0xf
    s_lshl_b32 s63, s63, 11
    s_nop 0
    s_add_u32 s63, s63, s62
    v_readlane_b32 s55, v128, 63
    v_add_u32 v200, s63, v1
    v_readlane_b32 s56, v129, 63
    ds_read_b128 v[176:179], v200
    s_nop 1
    ds_read_b128 v[180:183], v200 offset:1024
    v_mov_b32 v130, s55
    s_add_u32 s63, s6, 3
    v_mov_b32 v131, s56
    s_and_b32 s63, s63, 3
    v_mul_f32 v130, 0x3b000000, v130
    s_lshl_b32 s63, s63, 11
    v_mul_f32 v131, 0x3b000000, v131
    s_add_u32 s63, s63, s62
    v_fma_f32 v131, -v130, v130, v131
    v_add_u32 v200, s63, v1
    v_max_f32 v131, 0, v131
    ds_read_b128 v[184:187], v200
    v_add_f32 v131, 0x3727c5ac, v131
    ds_read_b128 v[188:191], v200 offset:1024
    v_rsq_f32 v131, v131
    s_waitcnt lgkmcnt(0)
    s_nop 0
    v_add_f32 v160, v160, v168
    v_mul_f32 v130, v130, v131
    v_add_f32 v161, v161, v169
    v_fma_f32 v112, v104, v131, -v130
    v_add_f32 v162, v162, v170
    v_fma_f32 v113, v105, v131, -v130
    v_add_f32 v163, v163, v171
    v_fma_f32 v114, v106, v131, -v130
    v_add_f32 v164, v164, v172
    v_fma_f32 v115, v107, v131, -v130
    v_add_f32 v165, v165, v173
    v_fma_f32 v116, v108, v131, -v130
    v_add_f32 v166, v166, v174
    v_fma_f32 v117, v109, v131, -v130
    v_add_f32 v167, v167, v175
    v_fma_f32 v118, v110, v131, -v130
    v_add_f32 v176, v176, v184
    v_fma_f32 v119, v111, v131, -v130
    v_add_f32 v177, v177, v185
    v_lshlrev_b32 v120, 16, v244
    v_add_f32 v178, v178, v186
    v_and_b32 v121, 0xffff0000, v244
    v_add_f32 v179, v179, v187
    v_lshlrev_b32 v122, 16, v245
    v_add_f32 v180, v180, v188
    v_and_b32 v123, 0xffff0000, v245
    v_add_f32 v181, v181, v189
    v_lshlrev_b32 v124, 16, v246
    v_add_f32 v182, v182, v190
    v_and_b32 v125, 0xffff0000, v246
    v_add_f32 v183, v183, v191
    v_lshlrev_b32 v126, 16, v247
    v_add_f32 v160, v160, v176
    v_and_b32 v127, 0xffff0000, v247
    v_add_f32 v161, v161, v177
    v_fmac_f32 v104, v112, v120
    v_add_f32 v162, v162, v178
    v_fmac_f32 v105, v113, v121
    v_add_f32 v163, v163, v179
    v_fmac_f32 v106, v114, v122
    v_add_f32 v164, v164, v180
    v_fmac_f32 v107, v115, v123
    v_add_f32 v165, v165, v181
    v_fmac_f32 v108, v116, v124
    v_add_f32 v166, v166, v182
    v_fmac_f32 v109, v117, v125
    v_add_f32 v167, v167, v183
    v_fmac_f32 v110, v118, v126
    v_cvt_pk_bf16_f32 v192, v160, v161
    v_fmac_f32 v111, v119, v127
    v_cvt_pk_bf16_f32 v193, v162, v163
    v_cvt_pk_bf16_f32 v240, v104, v105
    v_cvt_pk_bf16_f32 v194, v164, v165
    v_cvt_pk_bf16_f32 v241, v106, v107
    v_cvt_pk_bf16_f32 v195, v166, v167
    v_cvt_pk_bf16_f32 v242, v108, v109
    s_nop 1
    v_cvt_pk_bf16_f32 v243, v110, v111
    v_permlane32_swap_b32 v192, v194
    s_lshl_b32 s41, s4, 8
    v_permlane32_swap_b32 v193, v195
    s_lshl_b32 s40, s5, 2
    s_add_u32 s63, s21, 9437184
    s_add_u32 s41, s41, s40
    buffer_store_dwordx4 v[192:195], v5, s[8:11], s63 offen sc1
    s_add_u32 s41, s41, s6
    s_waitcnt vmcnt(0)
    s_add_u32 s41, s41, 0
    v_mov_b32 v214, 3
    v_mov_b32 v215, s27
    s_mov_b64 exec, 1
    s_cmp_eq_u32 s96, 0
    s_cbranch_scc1 L_hs_68
    buffer_store_byte v214, v215, s[8:11], 0 offen
    s_branch L_hs_68_e
L_hs_68:
    buffer_store_byte v214, v215, s[8:11], 0 offen sc1
L_hs_68_e:
    s_mov_b64 exec, -1
    s_lshl_b32 s41, s41, 10
    s_add_u32 s41, s41, 11534336
    buffer_store_dwordx4 v[240:243], v1, s[8:11], s41 offen sc1
    v_lshlrev_b32 v104, 16, v240
    v_and_b32 v105, 0xffff0000, v240
    v_lshlrev_b32 v106, 16, v241
    v_and_b32 v107, 0xffff0000, v241
    v_lshlrev_b32 v108, 16, v242
    v_and_b32 v109, 0xffff0000, v242
    v_lshlrev_b32 v110, 16, v243
    v_and_b32 v111, 0xffff0000, v243
    v_add_f32 v128, v104, v105
    v_mul_f32 v129, v104, v104
    v_add_f32 v130, v106, v107
    v_mul_f32 v131, v105, v105
    v_add_f32 v132, v108, v109
    v_fmac_f32 v129, v106, v106
    v_add_f32 v133, v110, v111
    v_fmac_f32 v131, v107, v107
    v_add_f32 v128, v128, v130
    v_fmac_f32 v129, v108, v108
    v_add_f32 v132, v132, v133
    v_fmac_f32 v131, v109, v109
    v_fmac_f32 v129, v110, v110
    v_fmac_f32 v131, v111, v111
    v_add_f32 v128, v128, v132
    v_add_f32 v129, v129, v131
    s_nop 0
    v_add_f32_dpp v128, v128, v128 row_shr:1 row_mask:0xf bank_mask:0xf bound_ctrl:0
    v_add_f32_dpp v129, v129, v129 row_shr:1 row_mask:0xf bank_mask:0xf bound_ctrl:0
    s_nop 0
    v_add_f32_dpp v128, v128, v128 row_shr:2 row_mask:0xf bank_mask:0xf bound_ctrl:0
    v_add_f32_dpp v129, v129, v129 row_shr:2 row_mask:0xf bank_mask:0xf bound_ctrl:0
    s_nop 0
    v_add_f32_dpp v128, v128, v128 row_shr:4 row_mask:0xf bank_mask:0xf bound_ctrl:0
    v_add_f32_dpp v129, v129, v129 row_shr:4 row_mask:0xf bank_mask:0xf bound_ctrl:0
    s_nop 0
    v_add_f32_dpp v128, v128, v128 row_shr:8 row_mask:0xf bank_mask:0xf bound_ctrl:0
    v_add_f32_dpp v129, v129, v129 row_shr:8 row_mask:0xf bank_mask:0xf bound_ctrl:0
    s_nop 0
    v_add_f32_dpp v128, v128, v128 row_bcast:15 row_mask:0xa bank_mask:0xf
    v_add_f32_dpp v129, v129, v129 row_bcast:15 row_mask:0xa bank_mask:0xf
    s_nop 0
    v_add_f32_dpp v128, v128, v128 row_bcast:31 row_mask:0xc bank_mask:0xf
    v_add_f32_dpp v129, v129, v129 row_bcast:31 row_mask:0xc bank_mask:0xf
    s_nop 0
    v_readlane_b32 s55, v128, 63
    v_readlane_b32 s56, v129, 63
    s_nop 1
    v_mov_b32 v130, s55
    v_mov_b32 v131, s56
    v_mul_f32 v130, 0x3b000000, v130
    v_mul_f32 v131, 0x3b000000, v131
    v_fma_f32 v131, -v130, v130, v131
    v_max_f32 v131, 0, v131
    v_add_f32 v131, 0x3727c5ac, v131
    v_rsq_f32 v131, v131
    s_nop 0
    v_mul_f32 v130, v130, v131
    v_fma_f32 v112, v104, v131, -v130
    v_fma_f32 v113, v105, v131, -v130
    v_fma_f32 v114, v106, v131, -v130
    v_fma_f32 v115, v107, v131, -v130
    v_fma_f32 v116, v108, v131, -v130
    v_fma_f32 v117, v109, v131, -v130
    v_fma_f32 v118, v110, v131, -v130
    v_fma_f32 v119, v111, v131, -v130
    v_cvt_pk_bf16_f32 v136, v112, v113
    v_cvt_pk_bf16_f32 v137, v114, v115
    v_cvt_pk_bf16_f32 v138, v116, v117
    v_cvt_pk_bf16_f32 v139, v118, v119
    s_mul_i32 s41, s6, 10256
    s_add_u32 s41, s41, 64
    v_add_u32 v140, s41, v1
    ds_write_b128 v140, v[136:139]
    s_waitcnt lgkmcnt(0)
    v_mov_b32 v142, 64896
    v_mov_b32 v143, 1
    s_add_u32 s22, s22, 4
    s_mov_b64 exec, 1
    ds_add_u32 v142, v143
    s_mov_b64 exec, -1
    s_mov_b32 s98, 0
L_s4_59:
    ds_read_b32 v143, v142
    s_waitcnt lgkmcnt(0)
    v_readfirstlane_b32 s61, v143
    s_add_u32 s98, s98, 1
    s_cmp_ge_u32 s61, s22
    s_cbranch_scc1 L_s4_59_d
    s_cmp_lt_u32 s98, 0x100000
    s_cbranch_scc1 L_s4_59
L_s4_59_d:
    v_lshrrev_b32 v140, 2, v0
    s_lshl_b32 s41, s6, 4
    v_add_u32 v140, s41, v140
    v_lshlrev_b32 v140, 4, v140
    v_and_b32 v141, 3, v0
    v_mul_u32_u24 v141, 10256, v141
    v_add_u32 v140, v140, v141
    v_add_u32 v140, 64, v140
    ds_read_b128 v[136:139], v140
    s_lshl_b32 s41, s4, 3
    s_lshr_b32 s40, s5, 3
    s_add_u32 s41, s41, s40
    s_add_u32 s41, s41, 0
    s_lshl_b32 s41, s41, 15
    s_and_b32 s40, s5, 7
    s_lshl_b32 s40, s40, 7
    s_add_u32 s41, s41, s40
    s_lshl_b32 s40, s6, 13
    s_add_u32 s41, s41, s40
    s_add_u32 s41, s41, 5242880
    v_lshrrev_b32 v140, 3, v0
    v_lshlrev_b32 v140, 10, v140
    v_and_b32 v141, 7, v0
    v_lshl_add_u32 v140, v141, 4, v140
    s_waitcnt lgkmcnt(0)
    s_cmp_eq_u32 s94, 0
    s_cbranch_scc1 L_hs_60
    buffer_store_dwordx4 v[136:139], v140, s[8:11], s41 offen
    s_branch L_hs_60_e
L_hs_60:
    buffer_store_dwordx4 v[136:139], v140, s[8:11], s41 offen sc1
L_hs_60_e:
    s_waitcnt vmcnt(0)
    v_mov_b32 v214, 4
    v_mov_b32 v215, s26
    s_mov_b64 exec, 1
    s_cmp_eq_u32 s96, 0
    s_cbranch_scc1 L_hs_61
    buffer_store_byte v214, v215, s[8:11], 0 offen
    s_branch L_hs_61_e
L_hs_61:
    buffer_store_byte v214, v215, s[8:11], 0 offen sc1
L_hs_61_e:
    s_mov_b64 exec, -1
    s_lshl_b32 s12, s4, 3
    s_add_u32 s12, s12, s6
    s_add_u32 s12, s12, 0
    s_mul_i32 s16, s12, 86
    s_add_u32 s16, s16, s95
    s_lshl_b32 s16, s16, 10
    s_add_u32 s16, s16, 13631488
    s_lshl_b32 s12, s12, 15
    s_add_u32 s12, s12, 5242880
    s_lshl_b32 s14, s4, 3
    s_lshr_b32 s62, s5, 3
    s_add_u32 s14, s14, s62
    s_add_u32 s14, s14, 0
    s_lshl_b32 s20, s14, 4
    s_and_b32 s62, s5, 7
    s_lshl_b32 s62, s62, 1
    s_add_u32 s20, s20, s62
    s_lshl_b32 s20, s20, 1
    s_add_u32 s20, s20, s6
    s_lshl_b32 s20, s20, 10
    s_lshl_b32 s32, s14, 15
    s_and_b32 s62, s5, 7
    s_lshl_b32 s62, s62, 7
    s_add_u32 s32, s32, s62
    s_lshl_b32 s62, s6, 5
    s_add_u32 s32, s32, s62
    s_mul_i32 s14, s14, 86
    s_mul_i32 s62, s6, 22
    s_cmp_eq_u32 s6, 3
    s_subb_u32 s62, s62, 0
    s_add_u32 s14, s14, s62
    s_lshl_b32 s14, s14, 10
    s_add_u32 s14, s14, 13631488
    s_add_u32 s18, s14, 21504
    s_cmp_lt_u32 s6, 2
    s_cselect_b32 s18, s18, 33554432
    s_lshl_b32 s13, s4, 3
    s_add_u32 s13, s13, s6
    s_add_u32 s13, s13, 4
    s_mul_i32 s17, s13, 86
    s_add_u32 s17, s17, s95
    s_lshl_b32 s17, s17, 10
    s_add_u32 s17, s17, 13631488
    s_lshl_b32 s13, s13, 15
    s_add_u32 s13, s13, 5242880
    s_lshl_b32 s15, s4, 3
    s_lshr_b32 s62, s5, 3
    s_add_u32 s15, s15, s62
    s_add_u32 s15, s15, 4
    s_lshl_b32 s21, s15, 4
    s_and_b32 s62, s5, 7
    s_lshl_b32 s62, s62, 1
    s_add_u32 s21, s21, s62
    s_lshl_b32 s21, s21, 1
    s_add_u32 s21, s21, s6
    s_lshl_b32 s21, s21, 10
    s_lshl_b32 s33, s15, 15
    s_and_b32 s62, s5, 7
    s_lshl_b32 s62, s62, 7
    s_add_u32 s33, s33, s62
    s_lshl_b32 s62, s6, 5
    s_add_u32 s33, s33, s62
    s_mul_i32 s15, s15, 86
    s_mul_i32 s62, s6, 22
    s_cmp_eq_u32 s6, 3
    s_subb_u32 s62, s62, 0
    s_add_u32 s15, s15, s62
    s_lshl_b32 s15, s15, 10
    s_add_u32 s15, s15, 13631488
    s_add_u32 s19, s15, 21504
    s_cmp_lt_u32 s6, 2
    s_cselect_b32 s19, s19, 33554432
    s_cmp_gt_u32 s5, 28
    s_cbranch_scc1 L_idle_77
    s_lshl_b32 s28, s6, 3
    s_mov_b32 s29, 0x80808080
    s_lshl_b32 s28, s28, 2
    s_add_u32 s28, s28, s24
    v_and_b32 v211, 7, v0
    v_lshlrev_b32 v211, 2, v211
    v_add_u32 v211, s28, v211
    s_mov_b32 s30, 2088533116
    buffer_load_dword v210, v211, s[8:11], 0 offen sc1
    s_waitcnt vmcnt(0)
    v_add_u32 v210, s30, v210
    v_and_b32 v210, s29, v210
    v_cmp_eq_u32 vcc, s29, v210
    s_cmp_eq_u64 vcc, -1
    s_cbranch_scc1 L_cf_78_d
    s_mov_b32 s98, 0
L_cf_78:
    buffer_load_dword v210, v211, s[8:11], 0 offen sc1
    s_waitcnt vmcnt(0)
    v_add_u32 v210, s30, v210
    v_and_b32 v210, s29, v210
    v_cmp_eq_u32 vcc, s29, v210
    s_add_u32 s98, s98, 1
    s_cmp_eq_u64 vcc, -1
    s_cbranch_scc1 L_cf_78_d
    s_cmp_lt_u32 s98, 0x8000
    s_cbranch_scc1 L_cf_78
L_cf_78_d:
    buffer_load_dwordx4 a[176:179], v2, s[8:11], s12 offen offset:0 sc1
    buffer_load_dwordx4 a[180:183], v2, s[8:11], s12 offen offset:1024 sc1
    buffer_load_dwordx4 a[184:187], v2, s[8:11], s12 offen offset:2048 sc1
    buffer_load_dwordx4 a[188:191], v2, s[8:11], s12 offen offset:3072 sc1
    s_add_u32 s12, s12, 4096
    buffer_load_dwordx4 a[192:195], v2, s[8:11], s12 offen offset:0 sc1
    buffer_load_dwordx4 a[196:199], v2, s[8:11], s12 offen offset:1024 sc1
    buffer_load_dwordx4 a[200:203], v2, s[8:11], s12 offen offset:2048 sc1
    buffer_load_dwordx4 a[204:207], v2, s[8:11], s12 offen offset:3072 sc1
    s_add_u32 s12, s12, 4096
    ds_read_b128 v[104:107], v3 offset:0
    ds_read_b128 v[108:111], v3 offset:32768
    ds_read_b128 v[112:115], v4 offset:0
    ds_read_b128 v[116:119], v3 offset:1024
    ds_read_b128 v[120:123], v3 offset:33792
    ds_read_b128 v[124:127], v4 offset:1024
    s_waitcnt vmcnt(7) lgkmcnt(3)
    v_mfma_f32_32x32x16_bf16 v[8:23], v[104:107], a[176:179], 0
    ds_read_b128 v[128:131], v3 offset:2048
    buffer_load_dwordx4 a[208:211], v2, s[8:11], s12 offen offset:0 sc1
    v_mfma_f32_32x32x16_bf16 v[24:39], v[108:111], a[176:179], 0
    ds_read_b128 v[132:135], v3 offset:34816
    v_mfma_f32_32x32x16_bf16 v[40:55], v[112:115], a[176:179], 0
    ds_read_b128 v[136:139], v4 offset:2048
    s_waitcnt vmcnt(7) lgkmcnt(3)
    v_mfma_f32_32x32x16_bf16 v[8:23], v[116:119], a[180:183], v[8:23]
    ds_read_b128 v[104:107], v3 offset:3072
    buffer_load_dwordx4 a[212:215], v2, s[8:11], s12 offen offset:1024 sc1
    v_mfma_f32_32x32x16_bf16 v[24:39], v[120:123], a[180:183], v[24:39]
    ds_read_b128 v[108:111], v3 offset:35840
    v_mfma_f32_32x32x16_bf16 v[40:55], v[124:127], a[180:183], v[40:55]
    ds_read_b128 v[112:115], v4 offset:3072
    s_waitcnt vmcnt(7) lgkmcnt(3)
    v_mfma_f32_32x32x16_bf16 v[8:23], v[128:131], a[184:187], v[8:23]
    ds_read_b128 v[116:119], v3 offset:4096
    buffer_load_dwordx4 a[176:179], v2, s[8:11], s12 offen offset:2048 sc1
    s_and_b32 s28, s5, 24
    s_mov_b32 s29, 0x80808080
    s_lshl_b32 s28, s28, 2
    s_add_u32 s28, s28, s25
    v_and_b32 v211, 7, v0
    v_lshlrev_b32 v211, 2, v211
    v_add_u32 v211, s28, v211
    s_mov_b32 s30, 2105376125
    buffer_load_dword v210, v211, s[8:11], 0 offen sc1
    v_mfma_f32_32x32x16_bf16 v[24:39], v[132:135], a[184:187], v[24:39]
    ds_read_b128 v[120:123], v3 offset:36864
    v_mfma_f32_32x32x16_bf16 v[40:55], v[136:139], a[184:187], v[40:55]
    ds_read_b128 v[124:127], v4 offset:4096
    s_waitcnt vmcnt(8) lgkmcnt(3)
    v_mfma_f32_32x32x16_bf16 v[8:23], v[104:107], a[188:191], v[8:23]
    ds_read_b128 v[128:131], v3 offset:5120
    buffer_load_dwordx4 a[180:183], v2, s[8:11], s12 offen offset:3072 sc1
    s_add_u32 s12, s12, 4096
    v_mfma_f32_32x32x16_bf16 v[24:39], v[108:111], a[188:191], v[24:39]
    ds_read_b128 v[132:135], v3 offset:37888
    v_mfma_f32_32x32x16_bf16 v[40:55], v[112:115], a[188:191], v[40:55]
    ds_read_b128 v[136:139], v4 offset:5120
    s_waitcnt vmcnt(8) lgkmcnt(3)
    v_mfma_f32_32x32x16_bf16 v[8:23], v[116:119], a[192:195], v[8:23]
    ds_read_b128 v[104:107], v3 offset:6144
    buffer_load_dwordx4 a[184:187], v2, s[8:11], s12 offen offset:0 sc1
    v_mfma_f32_32x32x16_bf16 v[24:39], v[120:123], a[192:195], v[24:39]
    ds_read_b128 v[108:111], v3 offset:38912
    v_mfma_f32_32x32x16_bf16 v[40:55], v[124:127], a[192:195], v[40:55]
    ds_read_b128 v[112:115], v4 offset:6144
    s_waitcnt vmcnt(8) lgkmcnt(3)
    v_mfma_f32_32x32x16_bf16 v[8:23], v[128:131], a[196:199], v[8:23]
    ds_read_b128 v[116:119], v3 offset:7168
    buffer_load_dwordx4 a[188:191], v2, s[8:11], s12 offen offset:1024 sc1
    v_mfma_f32_32x32x16_bf16 v[24:39], v[132:135], a[196:199], v[24:39]
    ds_read_b128 v[120:123], v3 offset:39936
    v_mfma_f32_32x32x16_bf16 v[40:55], v[136:139], a[196:199], v[40:55]
    ds_read_b128 v[124:127], v4 offset:7168
    s_waitcnt vmcnt(8) lgkmcnt(3)
    v_mfma_f32_32x32x16_bf16 v[8:23], v[104:107], a[200:203], v[8:23]
    ds_read_b128 v[128:131], v3 offset:8192
    buffer_load_dwordx4 a[192:195], v2, s[8:11], s12 offen offset:2048 sc1
    v_mfma_f32_32x32x16_bf16 v[24:39], v[108:111], a[200:203], v[24:39]
    ds_read_b128 v[132:135], v3 offset:40960
    s_waitcnt vmcnt(4)
    v_add_u32 v210, s30, v210
    v_and_b32 v210, s29, v210
    v_cmp_eq_u32 vcc, s29, v210
    s_cmp_eq_u64 vcc, -1
    s_cbranch_scc1 L_cf_69_d
    s_mov_b32 s98, 0
L_cf_69:
    buffer_load_dword v210, v211, s[8:11], 0 offen sc1
    s_waitcnt vmcnt(0)
    v_add_u32 v210, s30, v210
    v_and_b32 v210, s29, v210
    v_cmp_eq_u32 vcc, s29, v210
    s_add_u32 s98, s98, 1
    s_cmp_eq_u64 vcc, -1
    s_cbranch_scc1 L_cf_69_d
    s_cmp_lt_u32 s98, 0x8000
    s_cbranch_scc1 L_cf_69
L_cf_69_d:
    s_lshl_b32 s41, s4, 3
    v_mfma_f32_32x32x16_bf16 v[40:55], v[112:115], a[200:203], v[40:55]
    ds_read_b128 v[136:139], v4 offset:8192
    s_lshr_b32 s40, s5, 3
    s_add_u32 s41, s41, s40
    s_add_u32 s41, s41, 4
    s_lshl_b32 s41, s41, 15
    s_and_b32 s40, s5, 7
    s_waitcnt lgkmcnt(3)
    v_mfma_f32_32x32x16_bf16 v[8:23], v[116:119], a[204:207], v[8:23]
    ds_read_b128 v[104:107], v3 offset:9216
    buffer_load_dwordx4 a[196:199], v2, s[8:11], s12 offen offset:3072 sc1
    s_add_u32 s12, s12, 4096
    s_lshl_b32 s40, s40, 2
    s_add_u32 s40, s40, s6
    s_lshl_b32 s40, s40, 5
    s_add_u32 s41, s41, s40
    s_add_u32 s41, s41, 9437184
    v_mfma_f32_32x32x16_bf16 v[24:39], v[120:123], a[204:207], v[24:39]
    ds_read_b128 v[108:111], v3 offset:41984
    buffer_load_dwordx4 v[192:195], v7, s[8:11], s41 offen sc1
    v_lshlrev_b32 v160, 16, v248
    v_and_b32 v161, 0xffff0000, v248
    v_lshlrev_b32 v162, 16, v249
    v_and_b32 v163, 0xffff0000, v249
    v_mfma_f32_32x32x16_bf16 v[40:55], v[124:127], a[204:207], v[40:55]
    ds_read_b128 v[112:115], v4 offset:9216
    v_lshlrev_b32 v164, 16, v250
    v_and_b32 v165, 0xffff0000, v250
    v_lshlrev_b32 v166, 16, v251
    v_and_b32 v167, 0xffff0000, v251
    s_waitcnt lgkmcnt(3)
    v_mfma_f32_32x32x16_bf16 v[8:23], v[128:131], a[208:211], v[8:23]
    ds_read_b128 v[116:119], v3 offset:10240
    buffer_load_dwordx4 a[200:203], v2, s[8:11], s12 offen offset:0 sc1
    v_mfma_f32_32x32x16_bf16 v[24:39], v[132:135], a[208:211], v[24:39]
    ds_read_b128 v[120:123], v3 offset:43008
    v_mfma_f32_32x32x16_bf16 v[40:55], v[136:139], a[208:211], v[40:55]
    ds_read_b128 v[124:127], v4 offset:10240
    s_waitcnt lgkmcnt(3)
    v_mfma_f32_32x32x16_bf16 v[8:23], v[104:107], a[212:215], v[8:23]
    ds_read_b128 v[128:131], v3 offset:11264
    buffer_load_dwordx4 a[204:207], v2, s[8:11], s12 offen offset:1024 sc1
    v_mfma_f32_32x32x16_bf16 v[24:39], v[108:111], a[212:215], v[24:39]
    ds_read_b128 v[132:135], v3 offset:44032
    v_mfma_f32_32x32x16_bf16 v[40:55], v[112:115], a[212:215], v[40:55]
    ds_read_b128 v[136:139], v4 offset:11264
    s_waitcnt lgkmcnt(3)
    v_mfma_f32_32x32x16_bf16 v[8:23], v[116:119], a[176:179], v[8:23]
    ds_read_b128 v[104:107], v3 offset:12288
    buffer_load_dwordx4 a[208:211], v2, s[8:11], s12 offen offset:2048 sc1
    v_mfma_f32_32x32x16_bf16 v[24:39], v[120:123], a[176:179], v[24:39]
    ds_read_b128 v[108:111], v3 offset:45056
    v_mfma_f32_32x32x16_bf16 v[40:55], v[124:127], a[176:179], v[40:55]
    ds_read_b128 v[112:115], v4 offset:12288
    s_waitcnt vmcnt(8) lgkmcnt(3)
    v_mfma_f32_32x32x16_bf16 v[8:23], v[128:131], a[180:183], v[8:23]
    ds_read_b128 v[116:119], v3 offset:13312
    buffer_load_dwordx4 a[212:215], v2, s[8:11], s12 offen offset:3072 sc1
    s_add_u32 s12, s12, 4096
    v_mfma_f32_32x32x16_bf16 v[24:39], v[132:135], a[180:183], v[24:39]
    ds_read_b128 v[120:123], v3 offset:46080
    v_mfma_f32_32x32x16_bf16 v[40:55], v[136:139], a[180:183], v[40:55]
    ds_read_b128 v[124:127], v4 offset:13312
    s_waitcnt vmcnt(8) lgkmcnt(3)
    v_mfma_f32_32x32x16_bf16 v[8:23], v[104:107], a[184:187], v[8:23]
    ds_read_b128 v[128:131], v3 offset:14336
    buffer_load_dwordx4 a[176:179], v2, s[8:11], s12 offen offset:0 sc1
    s_waitcnt vmcnt(5)
    v_lshlrev_b32 v176, 16, v192
    v_and_b32 v177, 0xffff0000, v192
    v_lshlrev_b32 v178, 16, v193
    v_mfma_f32_32x32x16_bf16 v[24:39], v[108:111], a[184:187], v[24:39]
    ds_read_b128 v[132:135], v3 offset:47104
    v_and_b32 v179, 0xffff0000, v193
    v_lshlrev_b32 v180, 16, v194
    v_and_b32 v181, 0xffff0000, v194
    v_lshlrev_b32 v182, 16, v195
    v_and_b32 v183, 0xffff0000, v195
    v_mfma_f32_32x32x16_bf16 v[40:55], v[112:115], a[184:187], v[40:55]
    ds_read_b128 v[136:139], v4 offset:14336
    v_add_f32 v160, v160, v176
    v_add_f32 v161, v161, v177
    v_add_f32 v162, v162, v178
    v_add_f32 v163, v163, v179
    s_waitcnt lgkmcnt(3)
    v_mfma_f32_32x32x16_bf16 v[8:23], v[116:119], a[188:191], v[8:23]
    ds_read_b128 v[104:107], v3 offset:15360
    buffer_load_dwordx4 a[180:183], v2, s[8:11], s12 offen offset:1024 sc1
    v_add_f32 v164, v164, v180
    v_add_f32 v165, v165, v181
    v_add_f32 v166, v166, v182
    v_add_f32 v167, v167, v183
    v_cvt_pk_bf16_f32 v192, v160, v161
    v_mfma_f32_32x32x16_bf16 v[24:39], v[120:123], a[188:191], v[24:39]
    ds_read_b128 v[108:111], v3 offset:48128
    v_cvt_pk_bf16_f32 v193, v162, v163
    v_cvt_pk_bf16_f32 v194, v164, v165
    v_cvt_pk_bf16_f32 v195, v166, v167
    v_lshlrev_b32 v160, 16, v192
    v_and_b32 v161, 0xffff0000, v192
    v_mfma_f32_32x32x16_bf16 v[40:55], v[124:127], a[188:191], v[40:55]
    ds_read_b128 v[112:115], v4 offset:15360
    v_lshlrev_b32 v162, 16, v193
    v_and_b32 v163, 0xffff0000, v193
    v_lshlrev_b32 v164, 16, v194
    v_and_b32 v165, 0xffff0000, v194
    v_lshlrev_b32 v166, 16, v195
    s_waitcnt lgkmcnt(3)
    v_mfma_f32_32x32x16_bf16 v[8:23], v[128:131], a[192:195], v[8:23]
    ds_read_b128 v[116:119], v3 offset:16384
    buffer_load_dwordx4 a[184:187], v2, s[8:11], s12 offen offset:2048 sc1
    v_and_b32 v167, 0xffff0000, v195
    v_add_f32 v184, v160, v161
    v_mul_f32 v185, v160, v160
    v_add_f32 v186, v162, v163
    v_mul_f32 v187, v161, v161
    v_mfma_f32_32x32x16_bf16 v[24:39], v[132:135], a[192:195], v[24:39]
    ds_read_b128 v[120:123], v3 offset:49152
    v_add_f32 v188, v164, v165
    v_fmac_f32 v185, v162, v162
    v_add_f32 v189, v166, v167
    v_fmac_f32 v187, v163, v163
    v_add_f32 v184, v184, v186
    v_mfma_f32_32x32x16_bf16 v[40:55], v[136:139], a[192:195], v[40:55]
    ds_read_b128 v[124:127], v4 offset:16384
    v_fmac_f32 v185, v164, v164
    v_add_f32 v188, v188, v189
    v_fmac_f32 v187, v165, v165
    v_fmac_f32 v185, v166, v166
    s_waitcnt lgkmcnt(3)
    v_mfma_f32_32x32x16_bf16 v[8:23], v[104:107], a[196:199], v[8:23]
    ds_read_b128 v[128:131], v3 offset:17408
    buffer_load_dwordx4 a[188:191], v2, s[8:11], s12 offen offset:3072 sc1
    s_add_u32 s12, s12, 4096
    v_fmac_f32 v187, v167, v167
    v_add_f32 v184, v184, v188
    v_add_f32 v185, v185, v187
    s_nop 0
    v_add_f32_dpp v184, v184, v184 row_shr:1 row_mask:0xf bank_mask:0xf bound_ctrl:0
    v_mfma_f32_32x32x16_bf16 v[24:39], v[108:111], a[196:199], v[24:39]
    ds_read_b128 v[132:135], v3 offset:50176
    v_add_f32_dpp v185, v185, v185 row_shr:1 row_mask:0xf bank_mask:0xf bound_ctrl:0
    s_nop 0
    v_add_f32_dpp v184, v184, v184 row_shr:2 row_mask:0xf bank_mask:0xf bound_ctrl:0
    v_add_f32_dpp v185, v185, v185 row_shr:2 row_mask:0xf bank_mask:0xf bound_ctrl:0
    s_nop 0
    v_mfma_f32_32x32x16_bf16 v[40:55], v[112:115], a[196:199], v[40:55]
    ds_read_b128 v[136:139], v4 offset:17408
    v_add_f32_dpp v184, v184, v184 row_shr:4 row_mask:0xf bank_mask:0xf bound_ctrl:0
    v_add_f32_dpp v185, v185, v185 row_shr:4 row_mask:0xf bank_mask:0xf bound_ctrl:0
    s_nop 0
    v_add_f32_dpp v184, v184, v184 row_shr:8 row_mask:0xf bank_mask:0xf bound_ctrl:0
    v_add_f32_dpp v185, v185, v185 row_shr:8 row_mask:0xf bank_mask:0xf bound_ctrl:0
    s_waitcnt vmcnt(7) lgkmcnt(3)
    v_mfma_f32_32x32x16_bf16 v[8:23], v[116:119], a[200:203], v[8:23]
    ds_read_b128 v[104:107], v3 offset:18432
    buffer_load_dwordx4 a[192:195], v2, s[8:11], s12 offen offset:0 sc1
    s_nop 0
    v_add_f32_dpp v184, v184, v184 row_bcast:15 row_mask:0xa bank_mask:0xf
    v_add_f32_dpp v185, v185, v185 row_bcast:15 row_mask:0xa bank_mask:0xf
    s_nop 0
    v_add_f32_dpp v184, v184, v184 row_bcast:31 row_mask:0xc bank_mask:0xf
    v_mfma_f32_32x32x16_bf16 v[24:39], v[120:123], a[200:203], v[24:39]
    ds_read_b128 v[108:111], v3 offset:51200
    v_add_f32_dpp v185, v185, v185 row_bcast:31 row_mask:0xc bank_mask:0xf
    s_nop 0
    v_readlane_b32 s55, v184, 63
    v_readlane_b32 s56, v185, 63
    v_mfma_f32_32x32x16_bf16 v[40:55], v[124:127], a[200:203], v[40:55]
    ds_read_b128 v[112:115], v4 offset:18432
    s_nop 1
    v_mov_b32 v186, s55
    v_mov_b32 v187, s56
    v_mul_f32 v186, 0x3b000000, v186
    v_mul_f32 v187, 0x3b000000, v187
    s_waitcnt vmcnt(7) lgkmcnt(3)
    v_mfma_f32_32x32x16_bf16 v[8:23], v[128:131], a[204:207], v[8:23]
    ds_read_b128 v[116:119], v3 offset:19456
    buffer_load_dwordx4 a[196:199], v2, s[8:11], s12 offen offset:1024 sc1
    v_fma_f32 v187, -v186, v186, v187
    v_max_f32 v187, 0, v187
    v_add_f32 v187, 0x3727c5ac, v187
    v_rsq_f32 v187, v187
    v_mfma_f32_32x32x16_bf16 v[24:39], v[132:135], a[204:207], v[24:39]
    ds_read_b128 v[120:123], v3 offset:52224
    s_nop 0
    v_mul_f32 v186, v186, v187
    v_fma_f32 v168, v160, v187, -v186
    v_fma_f32 v169, v161, v187, -v186
    v_fma_f32 v170, v162, v187, -v186
    v_mfma_f32_32x32x16_bf16 v[40:55], v[136:139], a[204:207], v[40:55]
    ds_read_b128 v[124:127], v4 offset:19456
    v_fma_f32 v171, v163, v187, -v186
    v_fma_f32 v172, v164, v187, -v186
    v_fma_f32 v173, v165, v187, -v186
    v_fma_f32 v174, v166, v187, -v186
    v_fma_f32 v175, v167, v187, -v186
    s_waitcnt vmcnt(7) lgkmcnt(3)
    v_mfma_f32_32x32x16_bf16 v[8:23], v[104:107], a[208:211], v[8:23]
    ds_read_b128 v[128:131], v3 offset:20480
    buffer_load_dwordx4 a[200:203], v2, s[8:11], s12 offen offset:2048 sc1
    v_lshlrev_b32 v176, 16, v252
    v_and_b32 v177, 0xffff0000, v252
    v_lshlrev_b32 v178, 16, v253
    v_and_b32 v179, 0xffff0000, v253
    v_lshlrev_b32 v180, 16, v254
    v_mfma_f32_32x32x16_bf16 v[24:39], v[108:111], a[208:211], v[24:39]
    ds_read_b128 v[132:135], v3 offset:53248
    v_and_b32 v181, 0xffff0000, v254
    v_lshlrev_b32 v182, 16, v255
    v_and_b32 v183, 0xffff0000, v255
    v_fmac_f32 v160, v168, v176
    v_mfma_f32_32x32x16_bf16 v[40:55], v[112:115], a[208:211], v[40:55]
    ds_read_b128 v[136:139], v4 offset:20480
    v_fmac_f32 v161, v169, v177
    v_fmac_f32 v162, v170, v178
    v_fmac_f32 v163, v171, v179
    v_fmac_f32 v164, v172, v180
    v_fmac_f32 v165, v173, v181
    s_waitcnt vmcnt(7) lgkmcnt(3)
    v_mfma_f32_32x32x16_bf16 v[8:23], v[116:119], a[212:215], v[8:23]
    ds_read_b128 v[104:107], v3 offset:21504
    buffer_load_dwordx4 a[204:207], v2, s[8:11], s12 offen offset:3072 sc1
    s_add_u32 s12, s12, 4096
    v_fmac_f32 v166, v174, v182
    v_fmac_f32 v167, v175, v183
    v_cvt_pk_bf16_f32 v248, v160, v161
    v_cvt_pk_bf16_f32 v249, v162, v163
    v_cvt_pk_bf16_f32 v250, v164, v165
    v_mfma_f32_32x32x16_bf16 v[24:39], v[120:123], a[212:215], v[24:39]
    ds_read_b128 v[108:111], v3 offset:54272
    v_cvt_pk_bf16_f32 v251, v166, v167
    s_lshl_b32 s41, s4, 8
    s_lshl_b32 s40, s5, 2
    s_add_u32 s41, s41, s40
    s_add_u32 s41, s41, s6
    v_mfma_f32_32x32x16_bf16 v[40:55], v[124:127], a[212:215], v[40:55]
    ds_read_b128 v[112:115], v4 offset:21504
    s_add_u32 s41, s41, 128
    s_lshl_b32 s41, s41, 10
    s_add_u32 s41, s41, 11534336
    buffer_store_dwordx4 v[248:251], v1, s[8:11], s41 offen sc1
    v_lshlrev_b32 v160, 16, v248
    s_waitcnt vmcnt(8) lgkmcnt(3)
    v_mfma_f32_32x32x16_bf16 v[8:23], v[128:131], a[176:179], v[8:23]
    ds_read_b128 v[116:119], v3 offset:22528
    buffer_load_dwordx4 a[208:211], v2, s[8:11], s12 offen offset:0 sc1
    v_and_b32 v161, 0xffff0000, v248
    v_lshlrev_b32 v162, 16, v249
    v_and_b32 v163, 0xffff0000, v249
    v_lshlrev_b32 v164, 16, v250
    v_and_b32 v165, 0xffff0000, v250
    v_mfma_f32_32x32x16_bf16 v[24:39], v[132:135], a[176:179], v[24:39]
    ds_read_b128 v[120:123], v3 offset:55296
    v_lshlrev_b32 v166, 16, v251
    v_and_b32 v167, 0xffff0000, v251
    v_add_f32 v184, v160, v161
    v_mul_f32 v185, v160, v160
    v_mfma_f32_32x32x16_bf16 v[40:55], v[136:139], a[176:179], v[40:55]
    ds_read_b128 v[124:127], v4 offset:22528
    v_add_f32 v186, v162, v163
    v_mul_f32 v187, v161, v161
    v_add_f32 v188, v164, v165
    v_fmac_f32 v185, v162, v162
    v_add_f32 v189, v166, v167
    s_waitcnt vmcnt(8) lgkmcnt(3)
    v_mfma_f32_32x32x16_bf16 v[8:23], v[104:107], a[180:183], v[8:23]
    ds_read_b128 v[128:131], v3 offset:23552
    buffer_load_dwordx4 a[212:215], v2, s[8:11], s12 offen offset:1024 sc1
    v_fmac_f32 v187, v163, v163
    v_add_f32 v184, v184, v186
    v_fmac_f32 v185, v164, v164
    v_add_f32 v188, v188, v189
    v_fmac_f32 v187, v165, v165
    v_mfma_f32_32x32x16_bf16 v[24:39], v[108:111], a[180:183], v[24:39]
    ds_read_b128 v[132:135], v3 offset:56320
    v_fmac_f32 v185, v166, v166
    v_fmac_f32 v187, v167, v167
    v_add_f32 v184, v184, v188
    v_add_f32 v185, v185, v187
    s_nop 0
    v_mfma_f32_32x32x16_bf16 v[40:55], v[112:115], a[180:183], v[40:55]
    ds_read_b128 v[136:139], v4 offset:23552
    v_add_f32_dpp v184, v184, v184 row_shr:1 row_mask:0xf bank_mask:0xf bound_ctrl:0
    v_add_f32_dpp v185, v185, v185 row_shr:1 row_mask:0xf bank_mask:0xf bound_ctrl:0
    s_nop 0
    v_add_f32_dpp v184, v184, v184 row_shr:2 row_mask:0xf bank_mask:0xf bound_ctrl:0
    v_add_f32_dpp v185, v185, v185 row_shr:2 row_mask:0xf bank_mask:0xf bound_ctrl:0
    s_waitcnt vmcnt(8) lgkmcnt(3)
    v_mfma_f32_32x32x16_bf16 v[8:23], v[116:119], a[184:187], v[8:23]
    ds_read_b128 v[104:107], v3 offset:24576
    buffer_load_dwordx4 a[176:179], v2, s[8:11], s12 offen offset:2048 sc1
    s_nop 0
    v_add_f32_dpp v184, v184, v184 row_shr:4 row_mask:0xf bank_mask:0xf bound_ctrl:0
    v_add_f32_dpp v185, v185, v185 row_shr:4 row_mask:0xf bank_mask:0xf bound_ctrl:0
    s_nop 0
    v_add_f32_dpp v184, v184, v184 row_shr:8 row_mask:0xf bank_mask:0xf bound_ctrl:0
    v_mfma_f32_32x32x16_bf16 v[24:39], v[120:123], a[184:187], v[24:39]
    ds_read_b128 v[108:111], v3 offset:57344
    v_add_f32_dpp v185, v185, v185 row_shr:8 row_mask:0xf bank_mask:0xf bound_ctrl:0
    s_nop 0
    v_add_f32_dpp v184, v184, v184 row_bcast:15 row_mask:0xa bank_mask:0xf
    v_add_f32_dpp v185, v185, v185 row_bcast:15 row_mask:0xa bank_mask:0xf
    v_mfma_f32_32x32x16_bf16 v[40:55], v[124:127], a[184:187], v[40:55]
    ds_read_b128 v[112:115], v4 offset:24576
    s_nop 0
    v_add_f32_dpp v184, v184, v184 row_bcast:31 row_mask:0xc bank_mask:0xf
    v_add_f32_dpp v185, v185, v185 row_bcast:31 row_mask:0xc bank_mask:0xf
    s_nop 0
    v_readlane_b32 s55, v184, 63
    s_waitcnt vmcnt(8) lgkmcnt(3)
    v_mfma_f32_32x32x16_bf16 v[8:23], v[128:131], a[188:191], v[8:23]
    ds_read_b128 v[116:119], v3 offset:25600
    buffer_load_dwordx4 a[180:183], v2, s[8:11], s12 offen offset:3072 sc1
    v_readlane_b32 s56, v185, 63
    s_nop 1
    v_mov_b32 v186, s55
    v_mov_b32 v187, s56
    v_mul_f32 v186, 0x3b000000, v186
    v_mfma_f32_32x32x16_bf16 v[24:39], v[132:135], a[188:191], v[24:39]
    ds_read_b128 v[120:123], v3 offset:58368
    v_mul_f32 v187, 0x3b000000, v187
    v_fma_f32 v187, -v186, v186, v187
    v_max_f32 v187, 0, v187
    v_add_f32 v187, 0x3727c5ac, v187
    v_mfma_f32_32x32x16_bf16 v[40:55], v[136:139], a[188:191], v[40:55]
    ds_read_b128 v[124:127], v4 offset:25600
    v_rsq_f32 v187, v187
    s_nop 0
    v_mul_f32 v186, v186, v187
    v_fma_f32 v168, v160, v187, -v186
    v_fma_f32 v169, v161, v187, -v186
    s_waitcnt vmcnt(8) lgkmcnt(3)
    v_mfma_f32_32x32x16_bf16 v[8:23], v[104:107], a[192:195], v[8:23]
    ds_read_b128 v[128:131], v3 offset:26624
    v_fma_f32 v170, v162, v187, -v186
    v_fma_f32 v171, v163, v187, -v186
    v_fma_f32 v172, v164, v187, -v186
    v_fma_f32 v173, v165, v187, -v186
    v_mfma_f32_32x32x16_bf16 v[24:39], v[108:111], a[192:195], v[24:39]
    ds_read_b128 v[132:135], v3 offset:59392
    v_fma_f32 v174, v166, v187, -v186
    v_fma_f32 v175, v167, v187, -v186
    v_cvt_pk_bf16_f32 v192, v168, v169
    v_cvt_pk_bf16_f32 v193, v170, v171
    v_cvt_pk_bf16_f32 v194, v172, v173
    v_mfma_f32_32x32x16_bf16 v[40:55], v[112:115], a[192:195], v[40:55]
    ds_read_b128 v[136:139], v4 offset:26624
    v_cvt_pk_bf16_f32 v195, v174, v175
    s_mul_i32 s41, s6, 10256
    s_add_u32 s41, s41, 32832
    v_add_u32 v196, s41, v1
    ds_write_b128 v196, v[192:195]
    s_waitcnt vmcnt(7) lgkmcnt(4)
    v_mfma_f32_32x32x16_bf16 v[8:23], v[116:119], a[196:199], v[8:23]
    ds_read_b128 v[104:107], v3 offset:27648
    s_waitcnt lgkmcnt(0)
    v_mov_b32 v198, 64912
    v_mov_b32 v199, 1
    s_add_u32 s23, s23, 4
    s_mov_b64 exec, 1
    ds_add_u32 v198, v199
    s_mov_b64 exec, -1
    s_mov_b32 s98, 0
L_s4_70:
    ds_read_b32 v199, v198
    s_waitcnt lgkmcnt(0)
    v_readfirstlane_b32 s61, v199
    s_add_u32 s98, s98, 1
    s_cmp_ge_u32 s61, s23
    s_cbranch_scc1 L_s4_70_d
    s_cmp_lt_u32 s98, 0x100000
    s_cbranch_scc1 L_s4_70
L_s4_70_d:
    v_lshrrev_b32 v196, 2, v0
    s_lshl_b32 s41, s6, 4
    v_add_u32 v196, s41, v196
    v_mfma_f32_32x32x16_bf16 v[24:39], v[120:123], a[196:199], v[24:39]
    ds_read_b128 v[108:111], v3 offset:60416
    v_lshlrev_b32 v196, 4, v196
    v_and_b32 v197, 3, v0
    v_mul_u32_u24 v197, 10256, v197
    v_add_u32 v196, v196, v197
    v_add_u32 v196, 32832, v196
    v_mfma_f32_32x32x16_bf16 v[40:55], v[124:127], a[196:199], v[40:55]
    ds_read_b128 v[112:115], v4 offset:27648
    ds_read_b128 v[192:195], v196
    s_lshl_b32 s41, s4, 3
    s_lshr_b32 s40, s5, 3
    s_add_u32 s41, s41, s40
    s_add_u32 s41, s41, 4
    s_waitcnt vmcnt(6)
    v_mfma_f32_32x32x16_bf16 v[8:23], v[128:131], a[200:203], v[8:23]
    ds_read_b128 v[116:119], v3 offset:28672
    s_lshl_b32 s41, s41, 15
    s_and_b32 s40, s5, 7
    s_lshl_b32 s40, s40, 7
    s_add_u32 s41, s41, s40
    s_lshl_b32 s40, s6, 13
    v_mfma_f32_32x32x16_bf16 v[24:39], v[132:135], a[200:203], v[24:39]
    ds_read_b128 v[120:123], v3 offset:61440
    s_add_u32 s41, s41, s40
    s_add_u32 s41, s41, 5242880
    v_lshrrev_b32 v196, 3, v0
    v_lshlrev_b32 v196, 10, v196
    v_and_b32 v197, 7, v0
    v_mfma_f32_32x32x16_bf16 v[40:55], v[136:139], a[200:203], v[40:55]
    ds_read_b128 v[124:127], v4 offset:28672
    v_lshl_add_u32 v196, v197, 4, v196
    s_waitcnt lgkmcnt(3)
    s_cmp_eq_u32 s94, 0
    s_cbranch_scc1 L_hs_71
    buffer_store_dwordx4 v[192:195], v196, s[8:11], s41 offen
    s_branch L_hs_71_e
L_hs_71:
    buffer_store_dwordx4 v[192:195], v196, s[8:11], s41 offen sc1
L_hs_71_e:
    s_waitcnt vmcnt(6)
    v_mfma_f32_32x32x16_bf16 v[8:23], v[104:107], a[204:207], v[8:23]
    ds_read_b128 v[128:131], v3 offset:29696
    v_mfma_f32_32x32x16_bf16 v[24:39], v[108:111], a[204:207], v[24:39]
    ds_read_b128 v[132:135], v3 offset:62464
    v_mfma_f32_32x32x16_bf16 v[40:55], v[112:115], a[204:207], v[40:55]
    ds_read_b128 v[136:139], v4 offset:29696
    s_waitcnt vmcnt(4) lgkmcnt(3)
    v_mfma_f32_32x32x16_bf16 v[8:23], v[116:119], a[208:211], v[8:23]
    ds_read_b128 v[104:107], v3 offset:30720
    v_mfma_f32_32x32x16_bf16 v[24:39], v[120:123], a[208:211], v[24:39]
    ds_read_b128 v[108:111], v3 offset:63488
    v_mfma_f32_32x32x16_bf16 v[40:55], v[124:127], a[208:211], v[40:55]
    ds_read_b128 v[112:115], v4 offset:30720
    s_waitcnt vmcnt(3) lgkmcnt(3)
    v_mfma_f32_32x32x16_bf16 v[8:23], v[128:131], a[212:215], v[8:23]
    ds_read_b128 v[116:119], v3 offset:31744
    v_mfma_f32_32x32x16_bf16 v[24:39], v[132:135], a[212:215], v[24:39]
    ds_read_b128 v[120:123], v3 offset:64512
    v_mfma_f32_32x32x16_bf16 v[40:55], v[136:139], a[212:215], v[40:55]
    ds_read_b128 v[124:127], v4 offset:31744
    s_waitcnt vmcnt(2) lgkmcnt(3)
    v_mfma_f32_32x32x16_bf16 v[8:23], v[104:107], a[176:179], v[8:23]
    ds_read_b128 v[128:131], v3 offset:0
    v_mfma_f32_32x32x16_bf16 v[24:39], v[108:111], a[176:179], v[24:39]
    ds_read_b128 v[132:135], v3 offset:32768
    v_mfma_f32_32x32x16_bf16 v[40:55], v[112:115], a[176:179], v[40:55]
    ds_read_b128 v[136:139], v4 offset:0
    s_waitcnt vmcnt(1) lgkmcnt(3)
    v_mfma_f32_32x32x16_bf16 v[8:23], v[116:119], a[180:183], v[8:23]
    ds_read_b128 v[104:107], v3 offset:1024
    s_waitcnt vmcnt(0)
    v_mov_b32 v214, 4
    v_mov_b32 v215, s27
    s_mov_b64 exec, 1
    s_cmp_eq_u32 s96, 0
    s_cbranch_scc1 L_hs_72
    buffer_store_byte v214, v215, s[8:11], 0 offen
    s_branch L_hs_72_e
L_hs_72:
    buffer_store_byte v214, v215, s[8:11], 0 offen sc1
L_hs_72_e:
    s_mov_b64 exec, -1
    v_mfma_f32_32x32x16_bf16 v[24:39], v[120:123], a[180:183], v[24:39]
    ds_read_b128 v[108:111], v3 offset:33792
    v_mfma_f32_32x32x16_bf16 v[40:55], v[124:127], a[180:183], v[40:55]
    ds_read_b128 v[112:115], v4 offset:1024
    s_lshl_b32 s28, s6, 3
    s_mov_b32 s29, 0x80808080
    s_lshl_b32 s28, s28, 2
    s_add_u32 s28, s28, s25
    v_and_b32 v211, 7, v0
    v_lshlrev_b32 v211, 2, v211
    v_add_u32 v211, s28, v211
    s_mov_b32 s30, 2088533116
    buffer_load_dword v210, v211, s[8:11], 0 offen sc1
    s_waitcnt vmcnt(0)
    v_add_u32 v210, s30, v210
    v_and_b32 v210, s29, v210
    v_cmp_eq_u32 vcc, s29, v210
    s_cmp_eq_u64 vcc, -1
    s_cbranch_scc1 L_cf_79_d
    s_mov_b32 s98, 0
L_cf_79:
    buffer_load_dword v210, v211, s[8:11], 0 offen sc1
    s_waitcnt vmcnt(0)
    v_add_u32 v210, s30, v210
    v_and_b32 v210, s29, v210
    v_cmp_eq_u32 vcc, s29, v210
    s_add_u32 s98, s98, 1
    s_cmp_eq_u64 vcc, -1
    s_cbranch_scc1 L_cf_79_d
    s_cmp_lt_u32 s98, 0x8000
    s_cbranch_scc1 L_cf_79
L_cf_79_d:
    buffer_load_dwordx4 a[184:187], v2, s[8:11], s13 offen offset:0 sc1
    buffer_load_dwordx4 a[188:191], v2, s[8:11], s13 offen offset:1024 sc1
    buffer_load_dwordx4 a[192:195], v2, s[8:11], s13 offen offset:2048 sc1
    buffer_load_dwordx4 a[196:199], v2, s[8:11], s13 offen offset:3072 sc1
    s_add_u32 s13, s13, 4096
    buffer_load_dwordx4 a[200:203], v2, s[8:11], s13 offen offset:0 sc1
    buffer_load_dwordx4 a[204:207], v2, s[8:11], s13 offen offset:1024 sc1
    buffer_load_dwordx4 a[208:211], v2, s[8:11], s13 offen offset:2048 sc1
    buffer_load_dwordx4 a[212:215], v2, s[8:11], s13 offen offset:3072 sc1
    s_add_u32 s13, s13, 4096
    s_waitcnt vmcnt(7) lgkmcnt(3)
    v_mfma_f32_32x32x16_bf16 v[56:71], v[128:131], a[184:187], 0
    ds_read_b128 v[116:119], v3 offset:2048
    buffer_load_dwordx4 a[176:179], v2, s[8:11], s13 offen offset:0 sc1
    v_mfma_f32_32x32x16_bf16 v[72:87], v[132:135], a[184:187], 0
    ds_read_b128 v[120:123], v3 offset:34816
    v_mfma_f32_32x32x16_bf16 v[88:103], v[136:139], a[184:187], 0
    ds_read_b128 v[124:127], v4 offset:2048
    v_mul_f32 v140, 0xbfb8aa3b, v8
    v_mul_f32 v141, 0xbfb8aa3b, v9
    v_mul_f32 v142, 0xbfb8aa3b, v10
    v_mul_f32 v143, 0xbfb8aa3b, v11
    v_mul_f32 v144, 0xbfb8aa3b, v12
    v_mul_f32 v145, 0xbfb8aa3b, v13
    s_waitcnt vmcnt(7) lgkmcnt(3)
    v_mfma_f32_32x32x16_bf16 v[56:71], v[104:107], a[188:191], v[56:71]
    ds_read_b128 v[128:131], v3 offset:3072
    buffer_load_dwordx4 a[180:183], v2, s[8:11], s13 offen offset:1024 sc1
    v_mul_f32 v146, 0xbfb8aa3b, v14
    v_mul_f32 v147, 0xbfb8aa3b, v15
    v_exp_f32 v140, v140
    v_exp_f32 v141, v141
    v_mfma_f32_32x32x16_bf16 v[72:87], v[108:111], a[188:191], v[72:87]
    ds_read_b128 v[132:135], v3 offset:35840
    v_exp_f32 v142, v142
    v_exp_f32 v143, v143
    v_exp_f32 v144, v144
    v_exp_f32 v145, v145
    v_mfma_f32_32x32x16_bf16 v[88:103], v[112:115], a[188:191], v[88:103]
    ds_read_b128 v[136:139], v4 offset:3072
    v_exp_f32 v146, v146
    v_exp_f32 v147, v147
    v_mul_f32 v16, v8, v16
    s_waitcnt vmcnt(7) lgkmcnt(3)
    v_mfma_f32_32x32x16_bf16 v[56:71], v[116:119], a[192:195], v[56:71]
    ds_read_b128 v[104:107], v3 offset:4096
    buffer_load_dwordx4 a[184:187], v2, s[8:11], s13 offen offset:2048 sc1
    v_mul_f32 v17, v9, v17
    v_mul_f32 v18, v10, v18
    v_mul_f32 v19, v11, v19
    v_mul_f32 v20, v12, v20
    v_mul_f32 v21, v13, v21
    v_mul_f32 v22, v14, v22
    v_mul_f32 v23, v15, v23
    v_mfma_f32_32x32x16_bf16 v[72:87], v[120:123], a[192:195], v[72:87]
    ds_read_b128 v[108:111], v3 offset:36864
    v_add_f32 v140, 1.0, v140
    v_add_f32 v141, 1.0, v141
    v_add_f32 v142, 1.0, v142
    v_add_f32 v143, 1.0, v143
    v_add_f32 v144, 1.0, v144
    v_add_f32 v145, 1.0, v145
    v_mfma_f32_32x32x16_bf16 v[88:103], v[124:127], a[192:195], v[88:103]
    ds_read_b128 v[112:115], v4 offset:4096
    v_add_f32 v146, 1.0, v146
    v_add_f32 v147, 1.0, v147
    v_rcp_f32 v140, v140
    v_rcp_f32 v141, v141
    s_waitcnt vmcnt(7) lgkmcnt(3)
    v_mfma_f32_32x32x16_bf16 v[56:71], v[128:131], a[196:199], v[56:71]
    ds_read_b128 v[116:119], v3 offset:5120
    buffer_load_dwordx4 a[188:191], v2, s[8:11], s13 offen offset:3072 sc1
    s_add_u32 s13, s13, 4096
    v_rcp_f32 v142, v142
    v_rcp_f32 v143, v143
    v_rcp_f32 v144, v144
    v_mfma_f32_32x32x16_bf16 v[72:87], v[132:135], a[196:199], v[72:87]
    ds_read_b128 v[120:123], v3 offset:37888
    v_rcp_f32 v145, v145
    v_rcp_f32 v146, v146
    v_rcp_f32 v147, v147
    s_nop 0
    v_mfma_f32_32x32x16_bf16 v[88:103], v[136:139], a[196:199], v[88:103]
    ds_read_b128 v[124:127], v4 offset:5120
    v_mul_f32 v16, v16, v140
    v_mul_f32 v17, v17, v141
    v_mul_f32 v18, v18, v142
    v_mul_f32 v19, v19, v143
    v_mul_f32 v20, v20, v144
    v_mul_f32 v21, v21, v145
    s_waitcnt vmcnt(7) lgkmcnt(3)
    v_mfma_f32_32x32x16_bf16 v[56:71], v[104:107], a[200:203], v[56:71]
    ds_read_b128 v[128:131], v3 offset:6144
    buffer_load_dwordx4 a[192:195], v2, s[8:11], s13 offen offset:0 sc1
    v_mul_f32 v22, v22, v146
    v_mul_f32 v23, v23, v147
    v_cvt_pk_bf16_f32 v148, v16, v17
    v_cvt_pk_bf16_f32 v149, v18, v19
    v_cvt_pk_bf16_f32 v150, v20, v21
    v_cvt_pk_bf16_f32 v151, v22, v23
    s_cmp_eq_u32 s94, 0
    s_cbranch_scc1 L_hs_80
    buffer_store_dwordx4 v[148:151], v1, s[8:11], s16 offen offset:0
    s_branch L_hs_80_e
L_hs_80:
    buffer_store_dwordx4 v[148:151], v1, s[8:11], s16 offen offset:0 sc1
L_hs_80_e:
    v_mfma_f32_32x32x16_bf16 v[72:87], v[108:111], a[200:203], v[72:87]
    ds_read_b128 v[132:135], v3 offset:38912
    v_mul_f32 v140, 0xbfb8aa3b, v24
    v_mul_f32 v141, 0xbfb8aa3b, v25
    v_mul_f32 v142, 0xbfb8aa3b, v26
    v_mul_f32 v143, 0xbfb8aa3b, v27
    v_mul_f32 v144, 0xbfb8aa3b, v28
    v_mul_f32 v145, 0xbfb8aa3b, v29
    v_mfma_f32_32x32x16_bf16 v[88:103], v[112:115], a[200:203], v[88:103]
    ds_read_b128 v[136:139], v4 offset:6144
    v_mul_f32 v146, 0xbfb8aa3b, v30
    v_mul_f32 v147, 0xbfb8aa3b, v31
    v_exp_f32 v140, v140
    v_exp_f32 v141, v141
    s_waitcnt vmcnt(8) lgkmcnt(3)
    v_mfma_f32_32x32x16_bf16 v[56:71], v[116:119], a[204:207], v[56:71]
    ds_read_b128 v[104:107], v3 offset:7168
    buffer_load_dwordx4 a[196:199], v2, s[8:11], s13 offen offset:1024 sc1
    v_exp_f32 v142, v142
    v_exp_f32 v143, v143
    v_exp_f32 v144, v144
    v_mfma_f32_32x32x16_bf16 v[72:87], v[120:123], a[204:207], v[72:87]
    ds_read_b128 v[108:111], v3 offset:39936
    v_exp_f32 v145, v145
    v_exp_f32 v146, v146
    v_exp_f32 v147, v147
    v_mul_f32 v32, v24, v32
    v_mfma_f32_32x32x16_bf16 v[88:103], v[124:127], a[204:207], v[88:103]
    ds_read_b128 v[112:115], v4 offset:7168
    v_mul_f32 v33, v25, v33
    v_mul_f32 v34, v26, v34
    v_mul_f32 v35, v27, v35
    v_mul_f32 v36, v28, v36
    v_mul_f32 v37, v29, v37
    v_mul_f32 v38, v30, v38
    s_waitcnt vmcnt(8) lgkmcnt(3)
    v_mfma_f32_32x32x16_bf16 v[56:71], v[128:131], a[208:211], v[56:71]
    ds_read_b128 v[116:119], v3 offset:8192
    buffer_load_dwordx4 a[200:203], v2, s[8:11], s13 offen offset:2048 sc1
    v_mul_f32 v39, v31, v39
    v_add_f32 v140, 1.0, v140
    v_add_f32 v141, 1.0, v141
    v_add_f32 v142, 1.0, v142
    v_add_f32 v143, 1.0, v143
    v_add_f32 v144, 1.0, v144
    v_add_f32 v145, 1.0, v145
    v_mfma_f32_32x32x16_bf16 v[72:87], v[132:135], a[208:211], v[72:87]
    ds_read_b128 v[120:123], v3 offset:40960
    v_add_f32 v146, 1.0, v146
    v_add_f32 v147, 1.0, v147
    v_rcp_f32 v140, v140
    v_rcp_f32 v141, v141
    v_mfma_f32_32x32x16_bf16 v[88:103], v[136:139], a[208:211], v[88:103]
    ds_read_b128 v[124:127], v4 offset:8192
    v_rcp_f32 v142, v142
    v_rcp_f32 v143, v143
    v_rcp_f32 v144, v144
    s_waitcnt vmcnt(8) lgkmcnt(3)
    v_mfma_f32_32x32x16_bf16 v[56:71], v[104:107], a[212:215], v[56:71]
    ds_read_b128 v[128:131], v3 offset:9216
    buffer_load_dwordx4 a[204:207], v2, s[8:11], s13 offen offset:3072 sc1
    s_add_u32 s13, s13, 4096
    v_rcp_f32 v145, v145
    v_rcp_f32 v146, v146
    v_rcp_f32 v147, v147
    s_nop 0
    v_mfma_f32_32x32x16_bf16 v[72:87], v[108:111], a[212:215], v[72:87]
    ds_read_b128 v[132:135], v3 offset:41984
    v_mul_f32 v32, v32, v140
    v_mul_f32 v33, v33, v141
    v_mul_f32 v34, v34, v142
    v_mul_f32 v35, v35, v143
    v_mul_f32 v36, v36, v144
    v_mul_f32 v37, v37, v145
    v_mfma_f32_32x32x16_bf16 v[88:103], v[112:115], a[212:215], v[88:103]
    ds_read_b128 v[136:139], v4 offset:9216
    v_mul_f32 v38, v38, v146
    v_mul_f32 v39, v39, v147
    v_cvt_pk_bf16_f32 v152, v32, v33
    v_cvt_pk_bf16_f32 v153, v34, v35
    v_cvt_pk_bf16_f32 v154, v36, v37
    v_cvt_pk_bf16_f32 v155, v38, v39
    s_waitcnt vmcnt(8) lgkmcnt(3)
    v_mfma_f32_32x32x16_bf16 v[56:71], v[116:119], a[176:179], v[56:71]
    ds_read_b128 v[104:107], v3 offset:10240
    buffer_load_dwordx4 a[208:211], v2, s[8:11], s13 offen offset:0 sc1
    s_cmp_eq_u32 s94, 0
    s_cbranch_scc1 L_hs_81
    buffer_store_dwordx4 v[152:155], v1, s[8:11], s16 offen offset:1024
    s_branch L_hs_81_e
L_hs_81:
    buffer_store_dwordx4 v[152:155], v1, s[8:11], s16 offen offset:1024 sc1
L_hs_81_e:
    v_mul_f32 v140, 0xbfb8aa3b, v40
    v_mul_f32 v141, 0xbfb8aa3b, v41
    v_mul_f32 v142, 0xbfb8aa3b, v42
    v_mul_f32 v143, 0xbfb8aa3b, v43
    v_mul_f32 v144, 0xbfb8aa3b, v44
    v_mul_f32 v145, 0xbfb8aa3b, v45
    v_mfma_f32_32x32x16_bf16 v[72:87], v[120:123], a[176:179], v[72:87]
    ds_read_b128 v[108:111], v3 offset:43008
    v_mul_f32 v146, 0xbfb8aa3b, v46
    v_mul_f32 v147, 0xbfb8aa3b, v47
    v_exp_f32 v140, v140
    v_exp_f32 v141, v141
    v_mfma_f32_32x32x16_bf16 v[88:103], v[124:127], a[176:179], v[88:103]
    ds_read_b128 v[112:115], v4 offset:10240
    v_exp_f32 v142, v142
    v_exp_f32 v143, v143
    v_exp_f32 v144, v144
    s_waitcnt vmcnt(9) lgkmcnt(3)
    v_mfma_f32_32x32x16_bf16 v[56:71], v[128:131], a[180:183], v[56:71]
    ds_read_b128 v[116:119], v3 offset:11264
    buffer_load_dwordx4 a[212:215], v2, s[8:11], s13 offen offset:1024 sc1
    v_exp_f32 v145, v145
    v_exp_f32 v146, v146
    v_exp_f32 v147, v147
    v_mul_f32 v48, v40, v48
    v_mfma_f32_32x32x16_bf16 v[72:87], v[132:135], a[180:183], v[72:87]
    ds_read_b128 v[120:123], v3 offset:44032
    v_mul_f32 v49, v41, v49
    v_mul_f32 v50, v42, v50
    v_mul_f32 v51, v43, v51
    v_mul_f32 v52, v44, v52
    v_mul_f32 v53, v45, v53
    v_mul_f32 v54, v46, v54
    v_mfma_f32_32x32x16_bf16 v[88:103], v[136:139], a[180:183], v[88:103]
    ds_read_b128 v[124:127], v4 offset:11264
    v_mul_f32 v55, v47, v55
    v_add_f32 v140, 1.0, v140
    v_add_f32 v141, 1.0, v141
    v_add_f32 v142, 1.0, v142
    v_add_f32 v143, 1.0, v143
    v_add_f32 v144, 1.0, v144
    s_waitcnt vmcnt(9) lgkmcnt(3)
    v_mfma_f32_32x32x16_bf16 v[56:71], v[104:107], a[184:187], v[56:71]
    ds_read_b128 v[128:131], v3 offset:12288
    buffer_load_dwordx4 a[176:179], v2, s[8:11], s13 offen offset:2048 sc1
    v_add_f32 v145, 1.0, v145
    v_add_f32 v146, 1.0, v146
    v_add_f32 v147, 1.0, v147
    v_rcp_f32 v140, v140
    v_rcp_f32 v141, v141
    v_mfma_f32_32x32x16_bf16 v[72:87], v[108:111], a[184:187], v[72:87]
    ds_read_b128 v[132:135], v3 offset:45056
    v_rcp_f32 v142, v142
    v_rcp_f32 v143, v143
    v_rcp_f32 v144, v144
    v_mfma_f32_32x32x16_bf16 v[88:103], v[112:115], a[184:187], v[88:103]
    ds_read_b128 v[136:139], v4 offset:12288
    v_rcp_f32 v145, v145
    v_rcp_f32 v146, v146
    v_rcp_f32 v147, v147
    s_waitcnt vmcnt(9) lgkmcnt(3)
    v_mfma_f32_32x32x16_bf16 v[56:71], v[116:119], a[188:191], v[56:71]
    ds_read_b128 v[104:107], v3 offset:13312
    buffer_load_dwordx4 a[180:183], v2, s[8:11], s13 offen offset:3072 sc1
    s_add_u32 s13, s13, 4096
    s_nop 0
    v_mul_f32 v48, v48, v140
    v_mul_f32 v49, v49, v141
    v_mul_f32 v50, v50, v142
    v_mul_f32 v51, v51, v143
    v_mul_f32 v52, v52, v144
    v_mul_f32 v53, v53, v145
    v_mfma_f32_32x32x16_bf16 v[72:87], v[120:123], a[188:191], v[72:87]
    ds_read_b128 v[108:111], v3 offset:46080
    v_mul_f32 v54, v54, v146
    v_mul_f32 v55, v55, v147
    v_cvt_pk_bf16_f32 v156, v48, v49
    v_cvt_pk_bf16_f32 v157, v50, v51
    v_cvt_pk_bf16_f32 v158, v52, v53
    v_cvt_pk_bf16_f32 v159, v54, v55
    v_mfma_f32_32x32x16_bf16 v[88:103], v[124:127], a[188:191], v[88:103]
    ds_read_b128 v[112:115], v4 offset:13312
    s_cmp_eq_u32 s94, 0
    s_cbranch_scc1 L_hs_82
    buffer_store_dwordx4 v[156:159], v1, s[8:11], s16 offen offset:2048
    s_branch L_hs_82_e
L_hs_82:
    buffer_store_dwordx4 v[156:159], v1, s[8:11], s16 offen offset:2048 sc1
L_hs_82_e:
    s_waitcnt vmcnt(0)
    v_mov_b32 v214, 5
    v_mov_b32 v215, s26
    s_mov_b64 exec, 1
    s_cmp_eq_u32 s96, 0
    s_cbranch_scc1 L_hs_83
    buffer_store_byte v214, v215, s[8:11], 0 offen
    s_branch L_hs_83_e
L_hs_83:
    buffer_store_byte v214, v215, s[8:11], 0 offen sc1
L_hs_83_e:
    s_mov_b64 exec, -1
    s_waitcnt lgkmcnt(3)
    v_mfma_f32_32x32x16_bf16 v[56:71], v[128:131], a[192:195], v[56:71]
    ds_read_b128 v[116:119], v3 offset:14336
    buffer_load_dwordx4 a[184:187], v2, s[8:11], s13 offen offset:0 sc1
    v_mfma_f32_32x32x16_bf16 v[72:87], v[132:135], a[192:195], v[72:87]
    ds_read_b128 v[120:123], v3 offset:47104
    v_mfma_f32_32x32x16_bf16 v[88:103], v[136:139], a[192:195], v[88:103]
    ds_read_b128 v[124:127], v4 offset:14336
    s_waitcnt lgkmcnt(3)
    v_mfma_f32_32x32x16_bf16 v[56:71], v[104:107], a[196:199], v[56:71]
    ds_read_b128 v[128:131], v3 offset:15360
    buffer_load_dwordx4 a[188:191], v2, s[8:11], s13 offen offset:1024 sc1
    v_mfma_f32_32x32x16_bf16 v[72:87], v[108:111], a[196:199], v[72:87]
    ds_read_b128 v[132:135], v3 offset:48128
    v_mfma_f32_32x32x16_bf16 v[88:103], v[112:115], a[196:199], v[88:103]
    ds_read_b128 v[136:139], v4 offset:15360
    s_waitcnt lgkmcnt(3)
    v_mfma_f32_32x32x16_bf16 v[56:71], v[116:119], a[200:203], v[56:71]
    ds_read_b128 v[104:107], v3 offset:16384
    buffer_load_dwordx4 a[192:195], v2, s[8:11], s13 offen offset:2048 sc1
    v_mfma_f32_32x32x16_bf16 v[72:87], v[120:123], a[200:203], v[72:87]
    ds_read_b128 v[108:111], v3 offset:49152
    v_mfma_f32_32x32x16_bf16 v[88:103], v[124:127], a[200:203], v[88:103]
    ds_read_b128 v[112:115], v4 offset:16384
    s_waitcnt lgkmcnt(3)
    v_mfma_f32_32x32x16_bf16 v[56:71], v[128:131], a[204:207], v[56:71]
    ds_read_b128 v[116:119], v3 offset:17408
    buffer_load_dwordx4 a[196:199], v2, s[8:11], s13 offen offset:3072 sc1
    s_add_u32 s13, s13, 4096
    v_mfma_f32_32x32x16_bf16 v[72:87], v[132:135], a[204:207], v[72:87]
    ds_read_b128 v[120:123], v3 offset:50176
    v_mfma_f32_32x32x16_bf16 v[88:103], v[136:139], a[204:207], v[88:103]
    ds_read_b128 v[124:127], v4 offset:17408
    s_waitcnt lgkmcnt(3)
    v_mfma_f32_32x32x16_bf16 v[56:71], v[104:107], a[208:211], v[56:71]
    ds_read_b128 v[128:131], v3 offset:18432
    buffer_load_dwordx4 a[200:203], v2, s[8:11], s13 offen offset:0 sc1
    v_mfma_f32_32x32x16_bf16 v[72:87], v[108:111], a[208:211], v[72:87]
    ds_read_b128 v[132:135], v3 offset:51200
    v_mfma_f32_32x32x16_bf16 v[88:103], v[112:115], a[208:211], v[88:103]
    ds_read_b128 v[136:139], v4 offset:18432
    s_waitcnt lgkmcnt(3)
    v_mfma_f32_32x32x16_bf16 v[56:71], v[116:119], a[212:215], v[56:71]
    ds_read_b128 v[104:107], v3 offset:19456
    buffer_load_dwordx4 a[204:207], v2, s[8:11], s13 offen offset:1024 sc1
    v_mfma_f32_32x32x16_bf16 v[72:87], v[120:123], a[212:215], v[72:87]
    ds_read_b128 v[108:111], v3 offset:52224
    v_mfma_f32_32x32x16_bf16 v[88:103], v[124:127], a[212:215], v[88:103]
    ds_read_b128 v[112:115], v4 offset:19456
    s_waitcnt lgkmcnt(3)
    v_mfma_f32_32x32x16_bf16 v[56:71], v[128:131], a[176:179], v[56:71]
    ds_read_b128 v[116:119], v3 offset:20480
    buffer_load_dwordx4 a[208:211], v2, s[8:11], s13 offen offset:2048 sc1
    v_mfma_f32_32x32x16_bf16 v[72:87], v[132:135], a[176:179], v[72:87]
    ds_read_b128 v[120:123], v3 offset:53248
    v_mfma_f32_32x32x16_bf16 v[88:103], v[136:139], a[176:179], v[88:103]
    ds_read_b128 v[124:127], v4 offset:20480
    s_waitcnt lgkmcnt(3)
    v_mfma_f32_32x32x16_bf16 v[56:71], v[104:107], a[180:183], v[56:71]
    ds_read_b128 v[128:131], v3 offset:21504
    buffer_load_dwordx4 a[212:215], v2, s[8:11], s13 offen offset:3072 sc1
    s_add_u32 s13, s13, 4096
    v_mfma_f32_32x32x16_bf16 v[72:87], v[108:111], a[180:183], v[72:87]
    ds_read_b128 v[132:135], v3 offset:54272
    v_mfma_f32_32x32x16_bf16 v[88:103], v[112:115], a[180:183], v[88:103]
    ds_read_b128 v[136:139], v4 offset:21504
    s_waitcnt vmcnt(7) lgkmcnt(3)
    v_mfma_f32_32x32x16_bf16 v[56:71], v[116:119], a[184:187], v[56:71]
    ds_read_b128 v[104:107], v3 offset:22528
    buffer_load_dwordx4 a[176:179], v2, s[8:11], s13 offen offset:0 sc1
    v_mfma_f32_32x32x16_bf16 v[72:87], v[120:123], a[184:187], v[72:87]
    ds_read_b128 v[108:111], v3 offset:55296
    v_mfma_f32_32x32x16_bf16 v[88:103], v[124:127], a[184:187], v[88:103]
    ds_read_b128 v[112:115], v4 offset:22528
    s_waitcnt vmcnt(7) lgkmcnt(3)
    v_mfma_f32_32x32x16_bf16 v[56:71], v[128:131], a[188:191], v[56:71]
    ds_read_b128 v[116:119], v3 offset:23552
    buffer_load_dwordx4 a[180:183], v2, s[8:11], s13 offen offset:1024 sc1
    v_mfma_f32_32x32x16_bf16 v[72:87], v[132:135], a[188:191], v[72:87]
    ds_read_b128 v[120:123], v3 offset:56320
    v_mfma_f32_32x32x16_bf16 v[88:103], v[136:139], a[188:191], v[88:103]
    ds_read_b128 v[124:127], v4 offset:23552
    s_waitcnt vmcnt(7) lgkmcnt(3)
    v_mfma_f32_32x32x16_bf16 v[56:71], v[104:107], a[192:195], v[56:71]
    ds_read_b128 v[128:131], v3 offset:24576
    buffer_load_dwordx4 a[184:187], v2, s[8:11], s13 offen offset:2048 sc1
    v_mfma_f32_32x32x16_bf16 v[72:87], v[108:111], a[192:195], v[72:87]
    ds_read_b128 v[132:135], v3 offset:57344
    v_mfma_f32_32x32x16_bf16 v[88:103], v[112:115], a[192:195], v[88:103]
    ds_read_b128 v[136:139], v4 offset:24576
    s_waitcnt vmcnt(7) lgkmcnt(3)
    v_mfma_f32_32x32x16_bf16 v[56:71], v[116:119], a[196:199], v[56:71]
    ds_read_b128 v[104:107], v3 offset:25600
    buffer_load_dwordx4 a[188:191], v2, s[8:11], s13 offen offset:3072 sc1
    v_mfma_f32_32x32x16_bf16 v[72:87], v[120:123], a[196:199], v[72:87]
    ds_read_b128 v[108:111], v3 offset:58368
    v_mfma_f32_32x32x16_bf16 v[88:103], v[124:127], a[196:199], v[88:103]
    ds_read_b128 v[112:115], v4 offset:25600
    s_waitcnt vmcnt(7) lgkmcnt(3)
    v_mfma_f32_32x32x16_bf16 v[56:71], v[128:131], a[200:203], v[56:71]
    ds_read_b128 v[116:119], v3 offset:26624
    s_mul_i32 s28, s6, 7
    s_lshr_b32 s29, s5, 3
    s_lshl_b32 s29, s29, 3
    s_lshl_b32 s29, 0x80, s29
    s_lshl_b32 s28, s28, 2
    s_add_u32 s28, s28, s24
    v_and_b32 v211, 7, v0
    v_lshlrev_b32 v211, 2, v211
    v_add_u32 v211, s28, v211
    s_mov_b32 s30, 2071690107
    buffer_load_dword v210, v211, s[8:11], 0 offen sc1
    v_mfma_f32_32x32x16_bf16 v[72:87], v[132:135], a[200:203], v[72:87]
    ds_read_b128 v[120:123], v3 offset:59392
    v_mfma_f32_32x32x16_bf16 v[88:103], v[136:139], a[200:203], v[88:103]
    ds_read_b128 v[124:127], v4 offset:26624
    s_waitcnt vmcnt(7) lgkmcnt(3)
    v_mfma_f32_32x32x16_bf16 v[56:71], v[104:107], a[204:207], v[56:71]
    ds_read_b128 v[128:131], v3 offset:27648
    v_mfma_f32_32x32x16_bf16 v[72:87], v[108:111], a[204:207], v[72:87]
    ds_read_b128 v[132:135], v3 offset:60416
    v_mfma_f32_32x32x16_bf16 v[88:103], v[112:115], a[204:207], v[88:103]
    ds_read_b128 v[136:139], v4 offset:27648
    s_waitcnt vmcnt(6) lgkmcnt(3)
    v_mfma_f32_32x32x16_bf16 v[56:71], v[116:119], a[208:211], v[56:71]
    ds_read_b128 v[104:107], v3 offset:28672
    v_mfma_f32_32x32x16_bf16 v[72:87], v[120:123], a[208:211], v[72:87]
    ds_read_b128 v[108:111], v3 offset:61440
    v_mfma_f32_32x32x16_bf16 v[88:103], v[124:127], a[208:211], v[88:103]
    ds_read_b128 v[112:115], v4 offset:28672
    s_waitcnt vmcnt(0)
    v_add_u32 v210, s30, v210
    v_and_b32 v210, s29, v210
    v_cmp_eq_u32 vcc, s29, v210
    s_cmp_eq_u64 vcc, -1
    s_cbranch_scc1 L_cf_84_d
    s_mov_b32 s98, 0
L_cf_84:
    buffer_load_dword v210, v211, s[8:11], 0 offen sc1
    s_waitcnt vmcnt(0)
    v_add_u32 v210, s30, v210
    v_and_b32 v210, s29, v210
    v_cmp_eq_u32 vcc, s29, v210
    s_add_u32 s98, s98, 1
    s_cmp_eq_u64 vcc, -1
    s_cbranch_scc1 L_cf_84_d
    s_cmp_lt_u32 s98, 0x8000
    s_cbranch_scc1 L_cf_84
L_cf_84_d:
    buffer_load_dwordx4 a[216:219], v1, s[8:11], s14 offen offset:0 sc1
    s_waitcnt lgkmcnt(3)
    v_mfma_f32_32x32x16_bf16 v[56:71], v[128:131], a[212:215], v[56:71]
    ds_read_b128 v[116:119], v3 offset:29696
    v_mfma_f32_32x32x16_bf16 v[72:87], v[132:135], a[212:215], v[72:87]
    ds_read_b128 v[120:123], v3 offset:62464
    buffer_load_dwordx4 a[220:223], v1, s[8:11], s14 offen offset:1024 sc1
    v_mfma_f32_32x32x16_bf16 v[88:103], v[136:139], a[212:215], v[88:103]
    ds_read_b128 v[124:127], v4 offset:29696
    s_waitcnt lgkmcnt(3)
    v_mfma_f32_32x32x16_bf16 v[56:71], v[104:107], a[176:179], v[56:71]
    ds_read_b128 v[128:131], v3 offset:30720
    buffer_load_dwordx4 a[224:227], v1, s[8:11], s14 offen offset:2048 sc1
    v_mfma_f32_32x32x16_bf16 v[72:87], v[108:111], a[176:179], v[72:87]
    ds_read_b128 v[132:135], v3 offset:63488
    v_mfma_f32_32x32x16_bf16 v[88:103], v[112:115], a[176:179], v[88:103]
    ds_read_b128 v[136:139], v4 offset:30720
    buffer_load_dwordx4 a[228:231], v1, s[8:11], s14 offen offset:3072 sc1
    s_add_u32 s14, s14, 4096
    s_waitcnt lgkmcnt(3)
    v_mfma_f32_32x32x16_bf16 v[56:71], v[116:119], a[180:183], v[56:71]
    ds_read_b128 v[104:107], v3 offset:31744
    v_mfma_f32_32x32x16_bf16 v[72:87], v[120:123], a[180:183], v[72:87]
    ds_read_b128 v[108:111], v3 offset:64512
    buffer_load_dwordx4 a[232:235], v1, s[8:11], s14 offen offset:0 sc1
    v_mfma_f32_32x32x16_bf16 v[88:103], v[124:127], a[180:183], v[88:103]
    ds_read_b128 v[112:115], v4 offset:31744
    s_waitcnt lgkmcnt(3)
    v_mfma_f32_32x32x16_bf16 v[56:71], v[128:131], a[184:187], v[56:71]
    buffer_load_dwordx4 a[236:239], v1, s[8:11], s14 offen offset:1024 sc1
    v_mfma_f32_32x32x16_bf16 v[72:87], v[132:135], a[184:187], v[72:87]
    v_mfma_f32_32x32x16_bf16 v[88:103], v[136:139], a[184:187], v[88:103]
    buffer_load_dwordx4 a[240:243], v1, s[8:11], s14 offen offset:2048 sc1
    s_waitcnt lgkmcnt(0)
    v_mfma_f32_32x32x16_bf16 v[56:71], v[104:107], a[188:191], v[56:71]
    buffer_load_dwordx4 a[244:247], v1, s[8:11], s14 offen offset:3072 sc1
    v_mfma_f32_32x32x16_bf16 v[72:87], v[108:111], a[188:191], v[72:87]
    s_add_u32 s14, s14, 4096
    v_mfma_f32_32x32x16_bf16 v[88:103], v[112:115], a[188:191], v[88:103]
    s_waitcnt vmcnt(7)
    v_mfma_f32_32x32x16_bf16 v[8:23], a[0:3], a[216:219], 0
    buffer_load_dwordx4 a[248:251], v1, s[8:11], s14 offen offset:0 sc1
    v_mfma_f32_32x32x16_bf16 v[24:39], a[88:91], a[216:219], 0
    v_mul_f32 v140, 0xbfb8aa3b, v56
    v_mul_f32 v141, 0xbfb8aa3b, v57
    v_mul_f32 v142, 0xbfb8aa3b, v58
    v_mul_f32 v143, 0xbfb8aa3b, v59
    v_mul_f32 v144, 0xbfb8aa3b, v60
    s_waitcnt vmcnt(7)
    v_mfma_f32_32x32x16_bf16 v[8:23], a[4:7], a[220:223], v[8:23]
    buffer_load_dwordx4 a[252:255], v1, s[8:11], s14 offen offset:1024 sc1
    v_mul_f32 v145, 0xbfb8aa3b, v61
    v_mul_f32 v146, 0xbfb8aa3b, v62
    v_mul_f32 v147, 0xbfb8aa3b, v63
    v_exp_f32 v140, v140
    v_mfma_f32_32x32x16_bf16 v[24:39], a[92:95], a[220:223], v[24:39]
    v_exp_f32 v141, v141
    v_exp_f32 v142, v142
    v_exp_f32 v143, v143
    s_waitcnt vmcnt(7)
    v_mfma_f32_32x32x16_bf16 v[8:23], a[8:11], a[224:227], v[8:23]
    buffer_load_dwordx4 a[216:219], v1, s[8:11], s14 offen offset:2048 sc1
    v_exp_f32 v144, v144
    v_exp_f32 v145, v145
    v_mfma_f32_32x32x16_bf16 v[24:39], a[96:99], a[224:227], v[24:39]
    v_exp_f32 v146, v146
    v_exp_f32 v147, v147
    v_mul_f32 v64, v56, v64
    s_waitcnt vmcnt(7)
    v_mfma_f32_32x32x16_bf16 v[8:23], a[12:15], a[228:231], v[8:23]
    buffer_load_dwordx4 a[220:223], v1, s[8:11], s14 offen offset:3072 sc1
    s_add_u32 s14, s14, 4096
    v_mul_f32 v65, v57, v65
    v_mul_f32 v66, v58, v66
    v_mul_f32 v67, v59, v67
    v_mul_f32 v68, v60, v68
    v_mul_f32 v69, v61, v69
    v_mfma_f32_32x32x16_bf16 v[24:39], a[100:103], a[228:231], v[24:39]
    v_mul_f32 v70, v62, v70
    v_mul_f32 v71, v63, v71
    v_add_f32 v140, 1.0, v140
    v_add_f32 v141, 1.0, v141
    v_add_f32 v142, 1.0, v142
    s_waitcnt vmcnt(7)
    v_mfma_f32_32x32x16_bf16 v[8:23], a[16:19], a[232:235], v[8:23]
    buffer_load_dwordx4 a[224:227], v1, s[8:11], s14 offen offset:0 sc1
    v_add_f32 v143, 1.0, v143
    v_add_f32 v144, 1.0, v144
    v_add_f32 v145, 1.0, v145
    v_add_f32 v146, 1.0, v146
    v_add_f32 v147, 1.0, v147
    v_mfma_f32_32x32x16_bf16 v[24:39], a[104:107], a[232:235], v[24:39]
    v_rcp_f32 v140, v140
    v_rcp_f32 v141, v141
    v_rcp_f32 v142, v142
    s_waitcnt vmcnt(7)
    v_mfma_f32_32x32x16_bf16 v[8:23], a[20:23], a[236:239], v[8:23]
    buffer_load_dwordx4 a[228:231], v1, s[8:11], s14 offen offset:1024 sc1
    v_rcp_f32 v143, v143
    v_rcp_f32 v144, v144
    v_mfma_f32_32x32x16_bf16 v[24:39], a[108:111], a[236:239], v[24:39]
    v_rcp_f32 v145, v145
    v_rcp_f32 v146, v146
    v_rcp_f32 v147, v147
    s_waitcnt vmcnt(7)
    v_mfma_f32_32x32x16_bf16 v[8:23], a[24:27], a[240:243], v[8:23]
    buffer_load_dwordx4 a[232:235], v1, s[8:11], s14 offen offset:2048 sc1
    s_nop 0
    v_mul_f32 v64, v64, v140
    v_mul_f32 v65, v65, v141
    v_mul_f32 v66, v66, v142
    v_mfma_f32_32x32x16_bf16 v[24:39], a[112:115], a[240:243], v[24:39]
    v_mul_f32 v67, v67, v143
    v_mul_f32 v68, v68, v144
    v_mul_f32 v69, v69, v145
    v_mul_f32 v70, v70, v146
    v_mul_f32 v71, v71, v147
    s_waitcnt vmcnt(7)
    v_mfma_f32_32x32x16_bf16 v[8:23], a[28:31], a[244:247], v[8:23]
    buffer_load_dwordx4 a[236:239], v1, s[8:11], s14 offen offset:3072 sc1
    s_add_u32 s14, s14, 4096
    v_cvt_pk_bf16_f32 v148, v64, v65
    v_cvt_pk_bf16_f32 v149, v66, v67
    v_cvt_pk_bf16_f32 v150, v68, v69
    v_cvt_pk_bf16_f32 v151, v70, v71
    s_cmp_eq_u32 s94, 0
    s_cbranch_scc1 L_hs_85
    buffer_store_dwordx4 v[148:151], v1, s[8:11], s17 offen offset:0
    s_branch L_hs_85_e
L_hs_85:
    buffer_store_dwordx4 v[148:151], v1, s[8:11], s17 offen offset:0 sc1
L_hs_85_e:
    v_mfma_f32_32x32x16_bf16 v[24:39], a[116:119], a[244:247], v[24:39]
    v_mul_f32 v140, 0xbfb8aa3b, v72
    v_mul_f32 v141, 0xbfb8aa3b, v73
    v_mul_f32 v142, 0xbfb8aa3b, v74
    v_mul_f32 v143, 0xbfb8aa3b, v75
    v_mul_f32 v144, 0xbfb8aa3b, v76
    s_waitcnt vmcnt(8)
    v_mfma_f32_32x32x16_bf16 v[8:23], a[32:35], a[248:251], v[8:23]
    buffer_load_dwordx4 a[240:243], v1, s[8:11], s14 offen offset:0 sc1
    v_mul_f32 v145, 0xbfb8aa3b, v77
    v_mul_f32 v146, 0xbfb8aa3b, v78
    v_mul_f32 v147, 0xbfb8aa3b, v79
    v_exp_f32 v140, v140
    v_mfma_f32_32x32x16_bf16 v[24:39], a[120:123], a[248:251], v[24:39]
    v_exp_f32 v141, v141
    v_exp_f32 v142, v142
    v_exp_f32 v143, v143
    s_waitcnt vmcnt(8)
    v_mfma_f32_32x32x16_bf16 v[8:23], a[36:39], a[252:255], v[8:23]
    buffer_load_dwordx4 a[244:247], v1, s[8:11], s14 offen offset:1024 sc1
    v_exp_f32 v144, v144
    v_exp_f32 v145, v145
    v_mfma_f32_32x32x16_bf16 v[24:39], a[124:127], a[252:255], v[24:39]
    v_exp_f32 v146, v146
    v_exp_f32 v147, v147
    v_mul_f32 v80, v72, v80
    s_waitcnt vmcnt(8)
    v_mfma_f32_32x32x16_bf16 v[8:23], a[40:43], a[216:219], v[8:23]
    buffer_load_dwordx4 a[248:251], v1, s[8:11], s14 offen offset:2048 sc1
    v_mul_f32 v81, v73, v81
    v_mul_f32 v82, v74, v82
    v_mul_f32 v83, v75, v83
    v_mul_f32 v84, v76, v84
    v_mul_f32 v85, v77, v85
    v_mfma_f32_32x32x16_bf16 v[24:39], a[128:131], a[216:219], v[24:39]
    v_mul_f32 v86, v78, v86
    v_mul_f32 v87, v79, v87
    v_add_f32 v140, 1.0, v140
    v_add_f32 v141, 1.0, v141
    v_add_f32 v142, 1.0, v142
    s_waitcnt vmcnt(8)
    v_mfma_f32_32x32x16_bf16 v[8:23], a[44:47], a[220:223], v[8:23]
    buffer_load_dwordx4 a[252:255], v1, s[8:11], s14 offen offset:3072 sc1
    s_add_u32 s14, s14, 4096
    v_add_f32 v143, 1.0, v143
    v_add_f32 v144, 1.0, v144
    v_add_f32 v145, 1.0, v145
    v_add_f32 v146, 1.0, v146
    v_add_f32 v147, 1.0, v147
    v_mfma_f32_32x32x16_bf16 v[24:39], a[132:135], a[220:223], v[24:39]
    v_rcp_f32 v140, v140
    v_rcp_f32 v141, v141
    v_rcp_f32 v142, v142
    s_waitcnt vmcnt(8)
    v_mfma_f32_32x32x16_bf16 v[8:23], a[48:51], a[224:227], v[8:23]
    buffer_load_dwordx4 a[216:219], v1, s[8:11], s14 offen offset:0 sc1
    v_rcp_f32 v143, v143
    v_rcp_f32 v144, v144
    v_mfma_f32_32x32x16_bf16 v[24:39], a[136:139], a[224:227], v[24:39]
    v_rcp_f32 v145, v145
    v_rcp_f32 v146, v146
    v_rcp_f32 v147, v147
    s_waitcnt vmcnt(8)
    v_mfma_f32_32x32x16_bf16 v[8:23], a[52:55], a[228:231], v[8:23]
    buffer_load_dwordx4 a[220:223], v1, s[8:11], s18 offen sc1
    s_nop 0
    v_mul_f32 v80, v80, v140
    v_mul_f32 v81, v81, v141
    v_mul_f32 v82, v82, v142
    v_mfma_f32_32x32x16_bf16 v[24:39], a[140:143], a[228:231], v[24:39]
    v_mul_f32 v83, v83, v143
    v_mul_f32 v84, v84, v144
    v_mul_f32 v85, v85, v145
    v_mul_f32 v86, v86, v146
    v_mul_f32 v87, v87, v147
    s_waitcnt vmcnt(8)
    v_mfma_f32_32x32x16_bf16 v[8:23], a[56:59], a[232:235], v[8:23]
    v_cvt_pk_bf16_f32 v152, v80, v81
    v_cvt_pk_bf16_f32 v153, v82, v83
    v_cvt_pk_bf16_f32 v154, v84, v85
    v_cvt_pk_bf16_f32 v155, v86, v87
    s_cmp_eq_u32 s94, 0
    s_cbranch_scc1 L_hs_86
    buffer_store_dwordx4 v[152:155], v1, s[8:11], s17 offen offset:1024
    s_branch L_hs_86_e
L_hs_86:
    buffer_store_dwordx4 v[152:155], v1, s[8:11], s17 offen offset:1024 sc1
L_hs_86_e:
    v_mfma_f32_32x32x16_bf16 v[24:39], a[144:147], a[232:235], v[24:39]
    v_mul_f32 v140, 0xbfb8aa3b, v88
    v_mul_f32 v141, 0xbfb8aa3b, v89
    v_mul_f32 v142, 0xbfb8aa3b, v90
    v_mul_f32 v143, 0xbfb8aa3b, v91
    v_mul_f32 v144, 0xbfb8aa3b, v92
    s_waitcnt vmcnt(8)
    v_mfma_f32_32x32x16_bf16 v[8:23], a[60:63], a[236:239], v[8:23]
    v_mul_f32 v145, 0xbfb8aa3b, v93
    v_mul_f32 v146, 0xbfb8aa3b, v94
    v_mul_f32 v147, 0xbfb8aa3b, v95
    v_exp_f32 v140, v140
    v_mfma_f32_32x32x16_bf16 v[24:39], a[148:151], a[236:239], v[24:39]
    v_exp_f32 v141, v141
    v_exp_f32 v142, v142
    v_exp_f32 v143, v143
    s_waitcnt vmcnt(6)
    v_mfma_f32_32x32x16_bf16 v[8:23], a[64:67], a[240:243], v[8:23]
    v_exp_f32 v144, v144
    v_exp_f32 v145, v145
    v_mfma_f32_32x32x16_bf16 v[24:39], a[152:155], a[240:243], v[24:39]
    v_exp_f32 v146, v146
    v_exp_f32 v147, v147
    v_mul_f32 v96, v88, v96
    s_waitcnt vmcnt(5)
    v_mfma_f32_32x32x16_bf16 v[8:23], a[68:71], a[244:247], v[8:23]
    v_mul_f32 v97, v89, v97
    v_mul_f32 v98, v90, v98
    v_mul_f32 v99, v91, v99
    v_mul_f32 v100, v92, v100
    v_mul_f32 v101, v93, v101
    v_mfma_f32_32x32x16_bf16 v[24:39], a[156:159], a[244:247], v[24:39]
    v_mul_f32 v102, v94, v102
    v_mul_f32 v103, v95, v103
    v_add_f32 v140, 1.0, v140
    v_add_f32 v141, 1.0, v141
    v_add_f32 v142, 1.0, v142
    s_waitcnt vmcnt(4)
    v_mfma_f32_32x32x16_bf16 v[8:23], a[72:75], a[248:251], v[8:23]
    v_add_f32 v143, 1.0, v143
    v_add_f32 v144, 1.0, v144
    v_add_f32 v145, 1.0, v145
    v_add_f32 v146, 1.0, v146
    v_add_f32 v147, 1.0, v147
    v_mfma_f32_32x32x16_bf16 v[24:39], a[160:163], a[248:251], v[24:39]
    v_rcp_f32 v140, v140
    v_rcp_f32 v141, v141
    v_rcp_f32 v142, v142
    s_waitcnt vmcnt(3)
    v_mfma_f32_32x32x16_bf16 v[8:23], a[76:79], a[252:255], v[8:23]
    v_rcp_f32 v143, v143
    v_rcp_f32 v144, v144
    v_mfma_f32_32x32x16_bf16 v[24:39], a[164:167], a[252:255], v[24:39]
    v_rcp_f32 v145, v145
    v_rcp_f32 v146, v146
    v_rcp_f32 v147, v147
    s_waitcnt vmcnt(2)
    v_mfma_f32_32x32x16_bf16 v[8:23], a[80:83], a[216:219], v[8:23]
    s_nop 0
    v_mul_f32 v96, v96, v140
    v_mul_f32 v97, v97, v141
    v_mul_f32 v98, v98, v142
    v_mfma_f32_32x32x16_bf16 v[24:39], a[168:171], a[216:219], v[24:39]
    v_mul_f32 v99, v99, v143
    v_mul_f32 v100, v100, v144
    v_mul_f32 v101, v101, v145
    v_mul_f32 v102, v102, v146
    v_mul_f32 v103, v103, v147
    s_waitcnt vmcnt(1)
    v_mfma_f32_32x32x16_bf16 v[8:23], a[84:87], a[220:223], v[8:23]
    v_cvt_pk_bf16_f32 v156, v96, v97
    v_cvt_pk_bf16_f32 v157, v98, v99
    v_cvt_pk_bf16_f32 v158, v100, v101
    v_cvt_pk_bf16_f32 v159, v102, v103
    s_cmp_eq_u32 s94, 0
    s_cbranch_scc1 L_hs_87
    buffer_store_dwordx4 v[156:159], v1, s[8:11], s17 offen offset:2048
    s_branch L_hs_87_e
L_hs_87:
    buffer_store_dwordx4 v[156:159], v1, s[8:11], s17 offen offset:2048 sc1
L_hs_87_e:
    s_waitcnt vmcnt(0)
    v_mfma_f32_32x32x16_bf16 v[24:39], a[172:175], a[220:223], v[24:39]
    v_mov_b32 v214, 5
    v_mov_b32 v215, s27
    s_mov_b64 exec, 1
    s_cmp_eq_u32 s96, 0
    s_cbranch_scc1 L_hs_88
    buffer_store_byte v214, v215, s[8:11], 0 offen
    s_branch L_hs_88_e
L_hs_88:
    buffer_store_byte v214, v215, s[8:11], 0 offen sc1
L_hs_88_e:
    s_mov_b64 exec, -1
    s_waitcnt vmcnt(0) lgkmcnt(0)
    s_branch L_idle_77_j
L_idle_77:
    s_and_b32 s28, s5, 24
    s_mov_b32 s29, 0x80808080
    s_lshl_b32 s28, s28, 2
    s_add_u32 s28, s28, s25
    v_and_b32 v211, 7, v0
    v_lshlrev_b32 v211, 2, v211
    v_add_u32 v211, s28, v211
    s_mov_b32 s30, 2105376125
    buffer_load_dword v210, v211, s[8:11], 0 offen sc1
    s_waitcnt vmcnt(0)
    v_add_u32 v210, s30, v210
    v_and_b32 v210, s29, v210
    v_cmp_eq_u32 vcc, s29, v210
    s_cmp_eq_u64 vcc, -1
    s_cbranch_scc1 L_cf_73_d
    s_mov_b32 s98, 0
L_cf_73:
    buffer_load_dword v210, v211, s[8:11], 0 offen sc1
    s_waitcnt vmcnt(0)
    v_add_u32 v210, s30, v210
    v_and_b32 v210, s29, v210
    v_cmp_eq_u32 vcc, s29, v210
    s_add_u32 s98, s98, 1
    s_cmp_eq_u64 vcc, -1
    s_cbranch_scc1 L_cf_73_d
    s_cmp_lt_u32 s98, 0x8000
    s_cbranch_scc1 L_cf_73
L_cf_73_d:
    s_lshl_b32 s41, s4, 3
    s_lshr_b32 s40, s5, 3
    s_add_u32 s41, s41, s40
    s_add_u32 s41, s41, 4
    s_lshl_b32 s41, s41, 15
    s_and_b32 s40, s5, 7
    s_lshl_b32 s40, s40, 2
    s_add_u32 s40, s40, s6
    s_lshl_b32 s40, s40, 5
    s_add_u32 s41, s41, s40
    s_add_u32 s41, s41, 9437184
    buffer_load_dwordx4 v[192:195], v7, s[8:11], s41 offen sc1
    v_lshlrev_b32 v160, 16, v248
    v_and_b32 v161, 0xffff0000, v248
    v_lshlrev_b32 v162, 16, v249
    v_and_b32 v163, 0xffff0000, v249
    v_lshlrev_b32 v164, 16, v250
    v_and_b32 v165, 0xffff0000, v250
    v_lshlrev_b32 v166, 16, v251
    v_and_b32 v167, 0xffff0000, v251
    s_waitcnt vmcnt(0)
    v_lshlrev_b32 v176, 16, v192
    v_and_b32 v177, 0xffff0000, v192
    v_lshlrev_b32 v178, 16, v193
    v_and_b32 v179, 0xffff0000, v193
    v_lshlrev_b32 v180, 16, v194
    v_and_b32 v181, 0xffff0000, v194
    v_lshlrev_b32 v182, 16, v195
    v_and_b32 v183, 0xffff0000, v195
    v_add_f32 v160, v160, v176
    v_add_f32 v161, v161, v177
    v_add_f32 v162, v162, v178
    v_add_f32 v163, v163, v179
    v_add_f32 v164, v164, v180
    v_add_f32 v165, v165, v181
    v_add_f32 v166, v166, v182
    v_add_f32 v167, v167, v183
    v_cvt_pk_bf16_f32 v192, v160, v161
    v_cvt_pk_bf16_f32 v193, v162, v163
    v_cvt_pk_bf16_f32 v194, v164, v165
    v_cvt_pk_bf16_f32 v195, v166, v167
    v_lshlrev_b32 v160, 16, v192
    v_and_b32 v161, 0xffff0000, v192
    v_lshlrev_b32 v162, 16, v193
    v_and_b32 v163, 0xffff0000, v193
    v_lshlrev_b32 v164, 16, v194
    v_and_b32 v165, 0xffff0000, v194
    v_lshlrev_b32 v166, 16, v195
    v_and_b32 v167, 0xffff0000, v195
    v_add_f32 v184, v160, v161
    v_mul_f32 v185, v160, v160
    v_add_f32 v186, v162, v163
    v_mul_f32 v187, v161, v161
    v_add_f32 v188, v164, v165
    v_fmac_f32 v185, v162, v162
    v_add_f32 v189, v166, v167
    v_fmac_f32 v187, v163, v163
    v_add_f32 v184, v184, v186
    v_fmac_f32 v185, v164, v164
    v_add_f32 v188, v188, v189
    v_fmac_f32 v187, v165, v165
    v_fmac_f32 v185, v166, v166
    v_fmac_f32 v187, v167, v167
    v_add_f32 v184, v184, v188
    v_add_f32 v185, v185, v187
    s_nop 0
    v_add_f32_dpp v184, v184, v184 row_shr:1 row_mask:0xf bank_mask:0xf bound_ctrl:0
    v_add_f32_dpp v185, v185, v185 row_shr:1 row_mask:0xf bank_mask:0xf bound_ctrl:0
    s_nop 0
    v_add_f32_dpp v184, v184, v184 row_shr:2 row_mask:0xf bank_mask:0xf bound_ctrl:0
    v_add_f32_dpp v185, v185, v185 row_shr:2 row_mask:0xf bank_mask:0xf bound_ctrl:0
    s_nop 0
    v_add_f32_dpp v184, v184, v184 row_shr:4 row_mask:0xf bank_mask:0xf bound_ctrl:0
    v_add_f32_dpp v185, v185, v185 row_shr:4 row_mask:0xf bank_mask:0xf bound_ctrl:0
    s_nop 0
    v_add_f32_dpp v184, v184, v184 row_shr:8 row_mask:0xf bank_mask:0xf bound_ctrl:0
    v_add_f32_dpp v185, v185, v185 row_shr:8 row_mask:0xf bank_mask:0xf bound_ctrl:0
    s_nop 0
    v_add_f32_dpp v184, v184, v184 row_bcast:15 row_mask:0xa bank_mask:0xf
    v_add_f32_dpp v185, v185, v185 row_bcast:15 row_mask:0xa bank_mask:0xf
    s_nop 0
    v_add_f32_dpp v184, v184, v184 row_bcast:31 row_mask:0xc bank_mask:0xf
    v_add_f32_dpp v185, v185, v185 row_bcast:31 row_mask:0xc bank_mask:0xf
    s_nop 0
    v_readlane_b32 s55, v184, 63
    v_readlane_b32 s56, v185, 63
    s_nop 1
    v_mov_b32 v186, s55
    v_mov_b32 v187, s56
    v_mul_f32 v186, 0x3b000000, v186
    v_mul_f32 v187, 0x3b000000, v187
    v_fma_f32 v187, -v186, v186, v187
    v_max_f32 v187, 0, v187
    v_add_f32 v187, 0x3727c5ac, v187
    v_rsq_f32 v187, v187
    s_nop 0
    v_mul_f32 v186, v186, v187
    v_fma_f32 v168, v160, v187, -v186
    v_fma_f32 v169, v161, v187, -v186
    v_fma_f32 v170, v162, v187, -v186
    v_fma_f32 v171, v163, v187, -v186
    v_fma_f32 v172, v164, v187, -v186
    v_fma_f32 v173, v165, v187, -v186
    v_fma_f32 v174, v166, v187, -v186
    v_fma_f32 v175, v167, v187, -v186
    v_lshlrev_b32 v176, 16, v252
    v_and_b32 v177, 0xffff0000, v252
    v_lshlrev_b32 v178, 16, v253
    v_and_b32 v179, 0xffff0000, v253
    v_lshlrev_b32 v180, 16, v254
    v_and_b32 v181, 0xffff0000, v254
    v_lshlrev_b32 v182, 16, v255
    v_and_b32 v183, 0xffff0000, v255
    v_fmac_f32 v160, v168, v176
    v_fmac_f32 v161, v169, v177
    v_fmac_f32 v162, v170, v178
    v_fmac_f32 v163, v171, v179
    v_fmac_f32 v164, v172, v180
    v_fmac_f32 v165, v173, v181
    v_fmac_f32 v166, v174, v182
    v_fmac_f32 v167, v175, v183
    v_cvt_pk_bf16_f32 v248, v160, v161
    v_cvt_pk_bf16_f32 v249, v162, v163
    v_cvt_pk_bf16_f32 v250, v164, v165
    v_cvt_pk_bf16_f32 v251, v166, v167
    s_lshl_b32 s41, s4, 8
    s_lshl_b32 s40, s5, 2
    s_add_u32 s41, s41, s40
    s_add_u32 s41, s41, s6
    s_add_u32 s41, s41, 128
    s_lshl_b32 s41, s41, 10
    s_add_u32 s41, s41, 11534336
    buffer_store_dwordx4 v[248:251], v1, s[8:11], s41 offen sc1
    v_lshlrev_b32 v160, 16, v248
    v_and_b32 v161, 0xffff0000, v248
    v_lshlrev_b32 v162, 16, v249
    v_and_b32 v163, 0xffff0000, v249
    v_lshlrev_b32 v164, 16, v250
    v_and_b32 v165, 0xffff0000, v250
    v_lshlrev_b32 v166, 16, v251
    v_and_b32 v167, 0xffff0000, v251
    v_add_f32 v184, v160, v161
    v_mul_f32 v185, v160, v160
    v_add_f32 v186, v162, v163
    v_mul_f32 v187, v161, v161
    v_add_f32 v188, v164, v165
    v_fmac_f32 v185, v162, v162
    v_add_f32 v189, v166, v167
    v_fmac_f32 v187, v163, v163
    v_add_f32 v184, v184, v186
    v_fmac_f32 v185, v164, v164
    v_add_f32 v188, v188, v189
    v_fmac_f32 v187, v165, v165
    v_fmac_f32 v185, v166, v166
    v_fmac_f32 v187, v167, v167
    v_add_f32 v184, v184, v188
    v_add_f32 v185, v185, v187
    s_nop 0
    v_add_f32_dpp v184, v184, v184 row_shr:1 row_mask:0xf bank_mask:0xf bound_ctrl:0
    v_add_f32_dpp v185, v185, v185 row_shr:1 row_mask:0xf bank_mask:0xf bound_ctrl:0
    s_nop 0
    v_add_f32_dpp v184, v184, v184 row_shr:2 row_mask:0xf bank_mask:0xf bound_ctrl:0
    v_add_f32_dpp v185, v185, v185 row_shr:2 row_mask:0xf bank_mask:0xf bound_ctrl:0
    s_nop 0
    v_add_f32_dpp v184, v184, v184 row_shr:4 row_mask:0xf bank_mask:0xf bound_ctrl:0
    v_add_f32_dpp v185, v185, v185 row_shr:4 row_mask:0xf bank_mask:0xf bound_ctrl:0
    s_nop 0
    v_add_f32_dpp v184, v184, v184 row_shr:8 row_mask:0xf bank_mask:0xf bound_ctrl:0
    v_add_f32_dpp v185, v185, v185 row_shr:8 row_mask:0xf bank_mask:0xf bound_ctrl:0
    s_nop 0
    v_add_f32_dpp v184, v184, v184 row_bcast:15 row_mask:0xa bank_mask:0xf
    v_add_f32_dpp v185, v185, v185 row_bcast:15 row_mask:0xa bank_mask:0xf
    s_nop 0
    v_add_f32_dpp v184, v184, v184 row_bcast:31 row_mask:0xc bank_mask:0xf
    v_add_f32_dpp v185, v185, v185 row_bcast:31 row_mask:0xc bank_mask:0xf
    s_nop 0
    v_readlane_b32 s55, v184, 63
    v_readlane_b32 s56, v185, 63
    s_nop 1
    v_mov_b32 v186, s55
    v_mov_b32 v187, s56
    v_mul_f32 v186, 0x3b000000, v186
    v_mul_f32 v187, 0x3b000000, v187
    v_fma_f32 v187, -v186, v186, v187
    v_max_f32 v187, 0, v187
    v_add_f32 v187, 0x3727c5ac, v187
    v_rsq_f32 v187, v187
    s_nop 0
    v_mul_f32 v186, v186, v187
    v_fma_f32 v168, v160, v187, -v186
    v_fma_f32 v169, v161, v187, -v186
    v_fma_f32 v170, v162, v187, -v186
    v_fma_f32 v171, v163, v187, -v186
    v_fma_f32 v172, v164, v187, -v186
    v_fma_f32 v173, v165, v187, -v186
    v_fma_f32 v174, v166, v187, -v186
    v_fma_f32 v175, v167, v187, -v186
    v_cvt_pk_bf16_f32 v192, v168, v169
    v_cvt_pk_bf16_f32 v193, v170, v171
    v_cvt_pk_bf16_f32 v194, v172, v173
    v_cvt_pk_bf16_f32 v195, v174, v175
    s_mul_i32 s41, s6, 10256
    s_add_u32 s41, s41, 32832
    v_add_u32 v196, s41, v1
    ds_write_b128 v196, v[192:195]
    s_waitcnt lgkmcnt(0)
    v_mov_b32 v198, 64912
    v_mov_b32 v199, 1
    s_add_u32 s23, s23, 4
    s_mov_b64 exec, 1
    ds_add_u32 v198, v199
    s_mov_b64 exec, -1
    s_mov_b32 s98, 0
L_s4_74:
    ds_read_b32 v199, v198
    s_waitcnt lgkmcnt(0)
    v_readfirstlane_b32 s61, v199
    s_add_u32 s98, s98, 1
    s_cmp_ge_u32 s61, s23
    s_cbranch_scc1 L_s4_74_d
    s_cmp_lt_u32 s98, 0x100000
    s_cbranch_scc1 L_s4_74
L_s4_74_d:
    v_lshrrev_b32 v196, 2, v0
    s_lshl_b32 s41, s6, 4
    v_add_u32 v196, s41, v196
    v_lshlrev_b32 v196, 4, v196
    v_and_b32 v197, 3, v0
    v_mul_u32_u24 v197, 10256, v197
    v_add_u32 v196, v196, v197
    v_add_u32 v196, 32832, v196
    ds_read_b128 v[192:195], v196
    s_lshl_b32 s41, s4, 3
    s_lshr_b32 s40, s5, 3
    s_add_u32 s41, s41, s40
    s_add_u32 s41, s41, 4
    s_lshl_b32 s41, s41, 15
    s_and_b32 s40, s5, 7
    s_lshl_b32 s40, s40, 7
    s_add_u32 s41, s41, s40
    s_lshl_b32 s40, s6, 13
    s_add_u32 s41, s41, s40
    s_add_u32 s41, s41, 5242880
    v_lshrrev_b32 v196, 3, v0
    v_lshlrev_b32 v196, 10, v196
    v_and_b32 v197, 7, v0
    v_lshl_add_u32 v196, v197, 4, v196
    s_waitcnt lgkmcnt(0)
    s_cmp_eq_u32 s94, 0
    s_cbranch_scc1 L_hs_75
    buffer_store_dwordx4 v[192:195], v196, s[8:11], s41 offen
    s_branch L_hs_75_e
L_hs_75:
    buffer_store_dwordx4 v[192:195], v196, s[8:11], s41 offen sc1
L_hs_75_e:
    s_waitcnt vmcnt(0)
    v_mov_b32 v214, 4
    v_mov_b32 v215, s27
    s_mov_b64 exec, 1
    s_cmp_eq_u32 s96, 0
    s_cbranch_scc1 L_hs_76
    buffer_store_byte v214, v215, s[8:11], 0 offen
    s_branch L_hs_76_e
L_hs_76:
    buffer_store_byte v214, v215, s[8:11], 0 offen sc1
L_hs_76_e:
    s_mov_b64 exec, -1
    s_mul_i32 s28, s6, 7
    s_lshr_b32 s29, s5, 3
    s_lshl_b32 s29, s29, 3
    s_lshl_b32 s29, 0x80, s29
    s_lshl_b32 s28, s28, 2
    s_add_u32 s28, s28, s24
    v_and_b32 v211, 7, v0
    v_lshlrev_b32 v211, 2, v211
    v_add_u32 v211, s28, v211
    s_mov_b32 s30, 2071690107
    buffer_load_dword v210, v211, s[8:11], 0 offen sc1
    s_waitcnt vmcnt(0)
    v_add_u32 v210, s30, v210
    v_and_b32 v210, s29, v210
    v_cmp_eq_u32 vcc, s29, v210
    s_cmp_eq_u64 vcc, -1
    s_cbranch_scc1 L_cf_89_d
    s_mov_b32 s98, 0
L_cf_89:
    buffer_load_dword v210, v211, s[8:11], 0 offen sc1
    s_waitcnt vmcnt(0)
    v_add_u32 v210, s30, v210
    v_and_b32 v210, s29, v210
    v_cmp_eq_u32 vcc, s29, v210
    s_add_u32 s98, s98, 1
    s_cmp_eq_u64 vcc, -1
    s_cbranch_scc1 L_cf_89_d
    s_cmp_lt_u32 s98, 0x8000
    s_cbranch_scc1 L_cf_89
L_cf_89_d:
    buffer_load_dwordx4 a[216:219], v1, s[8:11], s14 offen offset:0 sc1
    buffer_load_dwordx4 a[220:223], v1, s[8:11], s14 offen offset:1024 sc1
    buffer_load_dwordx4 a[224:227], v1, s[8:11], s14 offen offset:2048 sc1
    buffer_load_dwordx4 a[228:231], v1, s[8:11], s14 offen offset:3072 sc1
    s_add_u32 s14, s14, 4096
    buffer_load_dwordx4 a[232:235], v1, s[8:11], s14 offen offset:0 sc1
    buffer_load_dwordx4 a[236:239], v1, s[8:11], s14 offen offset:1024 sc1
    buffer_load_dwordx4 a[240:243], v1, s[8:11], s14 offen offset:2048 sc1
    buffer_load_dwordx4 a[244:247], v1, s[8:11], s14 offen offset:3072 sc1
    s_add_u32 s14, s14, 4096
    s_waitcnt vmcnt(7)
    v_mfma_f32_32x32x16_bf16 v[8:23], a[0:3], a[216:219], 0
    buffer_load_dwordx4 a[248:251], v1, s[8:11], s14 offen offset:0 sc1
    v_mfma_f32_32x32x16_bf16 v[24:39], a[88:91], a[216:219], 0
    s_waitcnt vmcnt(7)
    v_mfma_f32_32x32x16_bf16 v[8:23], a[4:7], a[220:223], v[8:23]
    buffer_load_dwordx4 a[252:255], v1, s[8:11], s14 offen offset:1024 sc1
    v_mfma_f32_32x32x16_bf16 v[24:39], a[92:95], a[220:223], v[24:39]
    s_waitcnt vmcnt(7)
    v_mfma_f32_32x32x16_bf16 v[8:23], a[8:11], a[224:227], v[8:23]
    buffer_load_dwordx4 a[216:219], v1, s[8:11], s14 offen offset:2048 sc1
    v_mfma_f32_32x32x16_bf16 v[24:39], a[96:99], a[224:227], v[24:39]
    s_waitcnt vmcnt(7)
    v_mfma_f32_32x32x16_bf16 v[8:23], a[12:15], a[228:231], v[8:23]
    buffer_load_dwordx4 a[220:223], v1, s[8:11], s14 offen offset:3072 sc1
    s_add_u32 s14, s14, 4096
    v_mfma_f32_32x32x16_bf16 v[24:39], a[100:103], a[228:231], v[24:39]
    s_waitcnt vmcnt(7)
    v_mfma_f32_32x32x16_bf16 v[8:23], a[16:19], a[232:235], v[8:23]
    buffer_load_dwordx4 a[224:227], v1, s[8:11], s14 offen offset:0 sc1
    v_mfma_f32_32x32x16_bf16 v[24:39], a[104:107], a[232:235], v[24:39]
    s_waitcnt vmcnt(7)
    v_mfma_f32_32x32x16_bf16 v[8:23], a[20:23], a[236:239], v[8:23]
    buffer_load_dwordx4 a[228:231], v1, s[8:11], s14 offen offset:1024 sc1
    v_mfma_f32_32x32x16_bf16 v[24:39], a[108:111], a[236:239], v[24:39]
    s_waitcnt vmcnt(7)
    v_mfma_f32_32x32x16_bf16 v[8:23], a[24:27], a[240:243], v[8:23]
    buffer_load_dwordx4 a[232:235], v1, s[8:11], s14 offen offset:2048 sc1
    v_mfma_f32_32x32x16_bf16 v[24:39], a[112:115], a[240:243], v[24:39]
    s_waitcnt vmcnt(7)
    v_mfma_f32_32x32x16_bf16 v[8:23], a[28:31], a[244:247], v[8:23]
    buffer_load_dwordx4 a[236:239], v1, s[8:11], s14 offen offset:3072 sc1
    s_add_u32 s14, s14, 4096
    v_mfma_f32_32x32x16_bf16 v[24:39], a[116:119], a[244:247], v[24:39]
    s_waitcnt vmcnt(7)
    v_mfma_f32_32x32x16_bf16 v[8:23], a[32:35], a[248:251], v[8:23]
    buffer_load_dwordx4 a[240:243], v1, s[8:11], s14 offen offset:0 sc1
    v_mfma_f32_32x32x16_bf16 v[24:39], a[120:123], a[248:251], v[24:39]
    s_waitcnt vmcnt(7)
    v_mfma_f32_32x32x16_bf16 v[8:23], a[36:39], a[252:255], v[8:23]
    buffer_load_dwordx4 a[244:247], v1, s[8:11], s14 offen offset:1024 sc1
    v_mfma_f32_32x32x16_bf16 v[24:39], a[124:127], a[252:255], v[24:39]
    s_waitcnt vmcnt(7)
    v_mfma_f32_32x32x16_bf16 v[8:23], a[40:43], a[216:219], v[8:23]
    buffer_load_dwordx4 a[248:251], v1, s[8:11], s14 offen offset:2048 sc1
    v_mfma_f32_32x32x16_bf16 v[24:39], a[128:131], a[216:219], v[24:39]
    s_waitcnt vmcnt(7)
    v_mfma_f32_32x32x16_bf16 v[8:23], a[44:47], a[220:223], v[8:23]
    buffer_load_dwordx4 a[252:255], v1, s[8:11], s14 offen offset:3072 sc1
    s_add_u32 s14, s14, 4096
    v_mfma_f32_32x32x16_bf16 v[24:39], a[132:135], a[220:223], v[24:39]
    s_waitcnt vmcnt(7)
    v_mfma_f32_32x32x16_bf16 v[8:23], a[48:51], a[224:227], v[8:23]
    buffer_load_dwordx4 a[216:219], v1, s[8:11], s14 offen offset:0 sc1
    v_mfma_f32_32x32x16_bf16 v[24:39], a[136:139], a[224:227], v[24:39]
    s_waitcnt vmcnt(7)
    v_mfma_f32_32x32x16_bf16 v[8:23], a[52:55], a[228:231], v[8:23]
    buffer_load_dwordx4 a[220:223], v1, s[8:11], s18 offen sc1
    v_mfma_f32_32x32x16_bf16 v[24:39], a[140:143], a[228:231], v[24:39]
    s_waitcnt vmcnt(7)
    v_mfma_f32_32x32x16_bf16 v[8:23], a[56:59], a[232:235], v[8:23]
    v_mfma_f32_32x32x16_bf16 v[24:39], a[144:147], a[232:235], v[24:39]
    s_waitcnt vmcnt(6)
    v_mfma_f32_32x32x16_bf16 v[8:23], a[60:63], a[236:239], v[8:23]
    v_mfma_f32_32x32x16_bf16 v[24:39], a[148:151], a[236:239], v[24:39]
    s_waitcnt vmcnt(5)
    v_mfma_f32_32x32x16_bf16 v[8:23], a[64:67], a[240:243], v[8:23]
    v_mfma_f32_32x32x16_bf16 v[24:39], a[152:155], a[240:243], v[24:39]
    s_waitcnt vmcnt(4)
    v_mfma_f32_32x32x16_bf16 v[8:23], a[68:71], a[244:247], v[8:23]
    v_mfma_f32_32x32x16_bf16 v[24:39], a[156:159], a[244:247], v[24:39]
    s_waitcnt vmcnt(3)
    v_mfma_f32_32x32x16_bf16 v[8:23], a[72:75], a[248:251], v[8:23]
    v_mfma_f32_32x32x16_bf16 v[24:39], a[160:163], a[248:251], v[24:39]
    s_waitcnt vmcnt(2)
    v_mfma_f32_32x32x16_bf16 v[8:23], a[76:79], a[252:255], v[8:23]
    v_mfma_f32_32x32x16_bf16 v[24:39], a[164:167], a[252:255], v[24:39]
    s_waitcnt vmcnt(1)
    v_mfma_f32_32x32x16_bf16 v[8:23], a[80:83], a[216:219], v[8:23]
    v_mfma_f32_32x32x16_bf16 v[24:39], a[168:171], a[216:219], v[24:39]
    s_waitcnt vmcnt(0)
    v_mfma_f32_32x32x16_bf16 v[8:23], a[84:87], a[220:223], v[8:23]
    v_mfma_f32_32x32x16_bf16 v[24:39], a[172:175], a[220:223], v[24:39]
    s_waitcnt vmcnt(0) lgkmcnt(0)
L_idle_77_j:
    s_add_u32 s63, s32, 11534336
    buffer_load_dwordx4 v[196:199], v6, s[8:11], s63 offen sc1
    s_lshl_b32 s62, s6, 11
    s_add_u32 s62, s62, 0
    v_add_u32 v200, s62, v1
    s_nop 5
    s_nop 5
    s_cmp_eq_u32 s6, 0
    s_cbranch_scc1 L_own_91
    ds_write_b128 v200, v[8:11] offset:0
    ds_write_b128 v200, v[12:15] offset:1024
    s_branch L_own_91_n
L_own_91:
    v_mov_b32 v160, v8
    v_mov_b32 v161, v9
    v_mov_b32 v162, v10
    v_mov_b32 v163, v11
    v_mov_b32 v164, v12
    v_mov_b32 v165, v13
    v_mov_b32 v166, v14
    v_mov_b32 v167, v15
L_own_91_n:
    s_cmp_eq_u32 s6, 1
    s_cbranch_scc1 L_own_92
    ds_write_b128 v200, v[16:19] offset:8192
    ds_write_b128 v200, v[20:23] offset:9216
    s_branch L_own_92_n
L_own_92:
    v_mov_b32 v160, v16
    v_mov_b32 v161, v17
    v_mov_b32 v162, v18
    v_mov_b32 v163, v19
    v_mov_b32 v164, v20
    v_mov_b32 v165, v21
    v_mov_b32 v166, v22
    v_mov_b32 v167, v23
L_own_92_n:
    s_cmp_eq_u32 s6, 2
    s_cbranch_scc1 L_own_93
    ds_write_b128 v200, v[24:27] offset:16384
    ds_write_b128 v200, v[28:31] offset:17408
    s_branch L_own_93_n
L_own_93:
    v_mov_b32 v160, v24
    v_mov_b32 v161, v25
    v_mov_b32 v162, v26
    v_mov_b32 v163, v27
    v_mov_b32 v164, v28
    v_mov_b32 v165, v29
    v_mov_b32 v166, v30
    v_mov_b32 v167, v31
L_own_93_n:
    s_cmp_eq_u32 s6, 3
    s_cbranch_scc1 L_own_94
    ds_write_b128 v200, v[32:35] offset:24576
    ds_write_b128 v200, v[36:39] offset:25600
    s_branch L_own_94_n
L_own_94:
    v_mov_b32 v160, v32
    v_mov_b32 v161, v33
    v_mov_b32 v162, v34
    v_mov_b32 v163, v35
    v_mov_b32 v164, v36
    v_mov_b32 v165, v37
    v_mov_b32 v166, v38
    v_mov_b32 v167, v39
L_own_94_n:
    s_waitcnt lgkmcnt(0)
    s_waitcnt lgkmcnt(0)
    v_mov_b32 v202, 64896
    v_mov_b32 v203, 1
    s_add_u32 s22, s22, 4
    s_mov_b64 exec, 1
    ds_add_u32 v202, v203
    s_mov_b64 exec, -1
    s_mov_b32 s98, 0
L_s4_95:
    ds_read_b32 v203, v202
    s_waitcnt lgkmcnt(0)
    v_readfirstlane_b32 s61, v203
    s_add_u32 s98, s98, 1
    s_cmp_ge_u32 s61, s22
    s_cbranch_scc1 L_s4_95_d
    s_cmp_lt_u32 s98, 0x100000
    s_cbranch_scc1 L_s4_95
L_s4_95_d:
    s_mul_i32 s28, s6, 7
    s_lshr_b32 s29, s5, 3
    s_lshl_b32 s29, s29, 3
    s_lshl_b32 s29, 0x80, s29
    s_lshl_b32 s28, s28, 2
    s_add_u32 s28, s28, s25
    v_and_b32 v211, 7, v0
    v_lshlrev_b32 v211, 2, v211
    v_add_u32 v211, s28, v211
    s_mov_b32 s30, 2071690107
    buffer_load_dword v210, v211, s[8:11], 0 offen sc1
    s_lshl_b32 s62, s6, 13
    s_add_u32 s62, s62, 0
    s_add_u32 s63, s6, 1
    s_and_b32 s63, s63, 3
    s_lshl_b32 s63, s63, 11
    s_add_u32 s63, s63, s62
    v_add_u32 v200, s63, v1
    ds_read_b128 v[168:171], v200
    ds_read_b128 v[172:175], v200 offset:1024
    s_add_u32 s63, s6, 2
    s_and_b32 s63, s63, 3
    s_lshl_b32 s63, s63, 11
    s_add_u32 s63, s63, s62
    v_add_u32 v200, s63, v1
    ds_read_b128 v[176:179], v200
    ds_read_b128 v[180:183], v200 offset:1024
    s_add_u32 s63, s6, 3
    s_and_b32 s63, s63, 3
    s_lshl_b32 s63, s63, 11
    s_add_u32 s63, s63, s62
    v_add_u32 v200, s63, v1
    ds_read_b128 v[184:187], v200
    ds_read_b128 v[188:191], v200 offset:1024
    s_waitcnt lgkmcnt(0)
    v_add_f32 v160, v160, v168
    v_add_f32 v161, v161, v169
    v_add_f32 v162, v162, v170
    v_add_f32 v163, v163, v171
    v_add_f32 v164, v164, v172
    v_add_f32 v165, v165, v173
    v_add_f32 v166, v166, v174
    v_add_f32 v167, v167, v175
    v_add_f32 v176, v176, v184
    v_add_f32 v177, v177, v185
    v_add_f32 v178, v178, v186
    v_add_f32 v179, v179, v187
    v_add_f32 v180, v180, v188
    v_add_f32 v181, v181, v189
    v_add_f32 v182, v182, v190
    v_add_f32 v183, v183, v191
    v_add_f32 v160, v160, v176
    v_add_f32 v161, v161, v177
    v_add_f32 v162, v162, v178
    v_add_f32 v163, v163, v179
    v_add_f32 v164, v164, v180
    v_add_f32 v165, v165, v181
    v_add_f32 v166, v166, v182
    v_add_f32 v167, v167, v183
    v_cvt_pk_bf16_f32 v192, v160, v161
    v_cvt_pk_bf16_f32 v193, v162, v163
    v_cvt_pk_bf16_f32 v194, v164, v165
    v_cvt_pk_bf16_f32 v195, v166, v167
    s_nop 1
    v_permlane32_swap_b32 v192, v194
    v_permlane32_swap_b32 v193, v195
    s_waitcnt vmcnt(1)
    v_lshlrev_b32 v168, 16, v192
    v_and_b32 v169, 0xffff0000, v192
    v_lshlrev_b32 v170, 16, v193
    v_and_b32 v171, 0xffff0000, v193
    v_lshlrev_b32 v172, 16, v194
    v_and_b32 v173, 0xffff0000, v194
    v_lshlrev_b32 v174, 16, v195
    v_and_b32 v175, 0xffff0000, v195
    v_lshlrev_b32 v176, 16, v196
    v_and_b32 v177, 0xffff0000, v196
    v_lshlrev_b32 v178, 16, v197
    v_and_b32 v179, 0xffff0000, v197
    v_lshlrev_b32 v180, 16, v198
    v_and_b32 v181, 0xffff0000, v198
    v_lshlrev_b32 v182, 16, v199
    v_and_b32 v183, 0xffff0000, v199
    v_add_f32 v168, v168, v176
    v_add_f32 v169, v169, v177
    v_add_f32 v170, v170, v178
    v_add_f32 v171, v171, v179
    v_add_f32 v172, v172, v180
    v_add_f32 v173, v173, v181
    v_add_f32 v174, v174, v182
    v_add_f32 v175, v175, v183
    v_cvt_pk_bf16_f32 v192, v168, v169
    v_cvt_pk_bf16_f32 v193, v170, v171
    v_cvt_pk_bf16_f32 v194, v172, v173
    v_cvt_pk_bf16_f32 v195, v174, v175
    buffer_store_dwordx4 v[192:195], v6, s[44:47], s32 offen
    s_waitcnt vmcnt(1)
    v_add_u32 v210, s30, v210
    v_and_b32 v210, s29, v210
    v_cmp_eq_u32 vcc, s29, v210
    s_cmp_eq_u64 vcc, -1
    s_cbranch_scc1 L_cf_96_d
    s_mov_b32 s98, 0
L_cf_96:
    buffer_load_dword v210, v211, s[8:11], 0 offen sc1
    s_waitcnt vmcnt(0)
    v_add_u32 v210, s30, v210
    v_and_b32 v210, s29, v210
    v_cmp_eq_u32 vcc, s29, v210
    s_add_u32 s98, s98, 1
    s_cmp_eq_u64 vcc, -1
    s_cbranch_scc1 L_cf_96_d
    s_cmp_lt_u32 s98, 0x8000
    s_cbranch_scc1 L_cf_96
L_cf_96_d:
    buffer_load_dwordx4 a[224:227], v1, s[8:11], s15 offen offset:0 sc1
    buffer_load_dwordx4 a[228:231], v1, s[8:11], s15 offen offset:1024 sc1
    buffer_load_dwordx4 a[232:235], v1, s[8:11], s15 offen offset:2048 sc1
    buffer_load_dwordx4 a[236:239], v1, s[8:11], s15 offen offset:3072 sc1
    s_add_u32 s15, s15, 4096
    buffer_load_dwordx4 a[240:243], v1, s[8:11], s15 offen offset:0 sc1
    buffer_load_dwordx4 a[244:247], v1, s[8:11], s15 offen offset:1024 sc1
    buffer_load_dwordx4 a[248:251], v1, s[8:11], s15 offen offset:2048 sc1
    buffer_load_dwordx4 a[252:255], v1, s[8:11], s15 offen offset:3072 sc1
    s_add_u32 s15, s15, 4096
    s_waitcnt vmcnt(7)
    v_mfma_f32_32x32x16_bf16 v[56:71], a[0:3], a[224:227], 0
    buffer_load_dwordx4 a[216:219], v1, s[8:11], s15 offen offset:0 sc1
    v_mfma_f32_32x32x16_bf16 v[72:87], a[88:91], a[224:227], 0
    s_waitcnt vmcnt(7)
    v_mfma_f32_32x32x16_bf16 v[56:71], a[4:7], a[228:231], v[56:71]
    buffer_load_dwordx4 a[220:223], v1, s[8:11], s15 offen offset:1024 sc1
    v_mfma_f32_32x32x16_bf16 v[72:87], a[92:95], a[228:231], v[72:87]
    s_waitcnt vmcnt(7)
    v_mfma_f32_32x32x16_bf16 v[56:71], a[8:11], a[232:235], v[56:71]
    buffer_load_dwordx4 a[224:227], v1, s[8:11], s15 offen offset:2048 sc1
    v_mfma_f32_32x32x16_bf16 v[72:87], a[96:99], a[232:235], v[72:87]
    s_waitcnt vmcnt(7)
    v_mfma_f32_32x32x16_bf16 v[56:71], a[12:15], a[236:239], v[56:71]
    buffer_load_dwordx4 a[228:231], v1, s[8:11], s15 offen offset:3072 sc1
    s_add_u32 s15, s15, 4096
    v_mfma_f32_32x32x16_bf16 v[72:87], a[100:103], a[236:239], v[72:87]
    s_waitcnt vmcnt(7)
    v_mfma_f32_32x32x16_bf16 v[56:71], a[16:19], a[240:243], v[56:71]
    buffer_load_dwordx4 a[232:235], v1, s[8:11], s15 offen offset:0 sc1
    v_mfma_f32_32x32x16_bf16 v[72:87], a[104:107], a[240:243], v[72:87]
    s_waitcnt vmcnt(7)
    v_mfma_f32_32x32x16_bf16 v[56:71], a[20:23], a[244:247], v[56:71]
    buffer_load_dwordx4 a[236:239], v1, s[8:11], s15 offen offset:1024 sc1
    v_mfma_f32_32x32x16_bf16 v[72:87], a[108:111], a[244:247], v[72:87]
    s_waitcnt vmcnt(7)
    v_mfma_f32_32x32x16_bf16 v[56:71], a[24:27], a[248:251], v[56:71]
    buffer_load_dwordx4 a[240:243], v1, s[8:11], s15 offen offset:2048 sc1
    v_mfma_f32_32x32x16_bf16 v[72:87], a[112:115], a[248:251], v[72:87]
    s_waitcnt vmcnt(7)
    v_mfma_f32_32x32x16_bf16 v[56:71], a[28:31], a[252:255], v[56:71]
    buffer_load_dwordx4 a[244:247], v1, s[8:11], s15 offen offset:3072 sc1
    s_add_u32 s15, s15, 4096
    v_mfma_f32_32x32x16_bf16 v[72:87], a[116:119], a[252:255], v[72:87]
    s_waitcnt vmcnt(7)
    v_mfma_f32_32x32x16_bf16 v[56:71], a[32:35], a[216:219], v[56:71]
    buffer_load_dwordx4 a[248:251], v1, s[8:11], s15 offen offset:0 sc1
    v_mfma_f32_32x32x16_bf16 v[72:87], a[120:123], a[216:219], v[72:87]
    s_waitcnt vmcnt(7)
    v_mfma_f32_32x32x16_bf16 v[56:71], a[36:39], a[220:223], v[56:71]
    buffer_load_dwordx4 a[252:255], v1, s[8:11], s15 offen offset:1024 sc1
    v_mfma_f32_32x32x16_bf16 v[72:87], a[124:127], a[220:223], v[72:87]
    s_waitcnt vmcnt(7)
    v_mfma_f32_32x32x16_bf16 v[56:71], a[40:43], a[224:227], v[56:71]
    buffer_load_dwordx4 a[216:219], v1, s[8:11], s15 offen offset:2048 sc1
    v_mfma_f32_32x32x16_bf16 v[72:87], a[128:131], a[224:227], v[72:87]
    s_waitcnt vmcnt(7)
    v_mfma_f32_32x32x16_bf16 v[56:71], a[44:47], a[228:231], v[56:71]
    buffer_load_dwordx4 a[220:223], v1, s[8:11], s15 offen offset:3072 sc1
    s_add_u32 s15, s15, 4096
    v_mfma_f32_32x32x16_bf16 v[72:87], a[132:135], a[228:231], v[72:87]
    s_waitcnt vmcnt(7)
    v_mfma_f32_32x32x16_bf16 v[56:71], a[48:51], a[232:235], v[56:71]
    buffer_load_dwordx4 a[224:227], v1, s[8:11], s15 offen offset:0 sc1
    v_mfma_f32_32x32x16_bf16 v[72:87], a[136:139], a[232:235], v[72:87]
    s_waitcnt vmcnt(7)
    v_mfma_f32_32x32x16_bf16 v[56:71], a[52:55], a[236:239], v[56:71]
    buffer_load_dwordx4 a[228:231], v1, s[8:11], s19 offen sc1
    v_mfma_f32_32x32x16_bf16 v[72:87], a[140:143], a[236:239], v[72:87]
    s_waitcnt vmcnt(7)
    v_mfma_f32_32x32x16_bf16 v[56:71], a[56:59], a[240:243], v[56:71]
    v_mfma_f32_32x32x16_bf16 v[72:87], a[144:147], a[240:243], v[72:87]
    s_waitcnt vmcnt(6)
    v_mfma_f32_32x32x16_bf16 v[56:71], a[60:63], a[244:247], v[56:71]
    v_mfma_f32_32x32x16_bf16 v[72:87], a[148:151], a[244:247], v[72:87]
    s_waitcnt vmcnt(5)
    v_mfma_f32_32x32x16_bf16 v[56:71], a[64:67], a[248:251], v[56:71]
    v_mfma_f32_32x32x16_bf16 v[72:87], a[152:155], a[248:251], v[72:87]
    s_waitcnt vmcnt(4)
    v_mfma_f32_32x32x16_bf16 v[56:71], a[68:71], a[252:255], v[56:71]
    v_mfma_f32_32x32x16_bf16 v[72:87], a[156:159], a[252:255], v[72:87]
    s_waitcnt vmcnt(3)
    v_mfma_f32_32x32x16_bf16 v[56:71], a[72:75], a[216:219], v[56:71]
    v_mfma_f32_32x32x16_bf16 v[72:87], a[160:163], a[216:219], v[72:87]
    s_waitcnt vmcnt(2)
    v_mfma_f32_32x32x16_bf16 v[56:71], a[76:79], a[220:223], v[56:71]
    v_mfma_f32_32x32x16_bf16 v[72:87], a[164:167], a[220:223], v[72:87]
    s_waitcnt vmcnt(1)
    v_mfma_f32_32x32x16_bf16 v[56:71], a[80:83], a[224:227], v[56:71]
    v_mfma_f32_32x32x16_bf16 v[72:87], a[168:171], a[224:227], v[72:87]
    s_waitcnt vmcnt(0)
    v_mfma_f32_32x32x16_bf16 v[56:71], a[84:87], a[228:231], v[56:71]
    v_mfma_f32_32x32x16_bf16 v[72:87], a[172:175], a[228:231], v[72:87]
    s_add_u32 s63, s33, 11534336
    buffer_load_dwordx4 v[196:199], v6, s[8:11], s63 offen sc1
    s_lshl_b32 s62, s6, 11
    s_add_u32 s62, s62, 32768
    v_add_u32 v200, s62, v1
    s_nop 5
    s_nop 5
    s_cmp_eq_u32 s6, 0
    s_cbranch_scc1 L_own_98
    ds_write_b128 v200, v[56:59] offset:0
    ds_write_b128 v200, v[60:63] offset:1024
    s_branch L_own_98_n
L_own_98:
    v_mov_b32 v160, v56
    v_mov_b32 v161, v57
    v_mov_b32 v162, v58
    v_mov_b32 v163, v59
    v_mov_b32 v164, v60
    v_mov_b32 v165, v61
    v_mov_b32 v166, v62
    v_mov_b32 v167, v63
L_own_98_n:
    s_cmp_eq_u32 s6, 1
    s_cbranch_scc1 L_own_99
    ds_write_b128 v200, v[64:67] offset:8192
    ds_write_b128 v200, v[68:71] offset:9216
    s_branch L_own_99_n
L_own_99:
    v_mov_b32 v160, v64
    v_mov_b32 v161, v65
    v_mov_b32 v162, v66
    v_mov_b32 v163, v67
    v_mov_b32 v164, v68
    v_mov_b32 v165, v69
    v_mov_b32 v166, v70
    v_mov_b32 v167, v71
L_own_99_n:
    s_cmp_eq_u32 s6, 2
    s_cbranch_scc1 L_own_100
    ds_write_b128 v200, v[72:75] offset:16384
    ds_write_b128 v200, v[76:79] offset:17408
    s_branch L_own_100_n
L_own_100:
    v_mov_b32 v160, v72
    v_mov_b32 v161, v73
    v_mov_b32 v162, v74
    v_mov_b32 v163, v75
    v_mov_b32 v164, v76
    v_mov_b32 v165, v77
    v_mov_b32 v166, v78
    v_mov_b32 v167, v79
L_own_100_n:
    s_cmp_eq_u32 s6, 3
    s_cbranch_scc1 L_own_101
    ds_write_b128 v200, v[80:83] offset:24576
    ds_write_b128 v200, v[84:87] offset:25600
    s_branch L_own_101_n
L_own_101:
    v_mov_b32 v160, v80
    v_mov_b32 v161, v81
    v_mov_b32 v162, v82
    v_mov_b32 v163, v83
    v_mov_b32 v164, v84
    v_mov_b32 v165, v85
    v_mov_b32 v166, v86
    v_mov_b32 v167, v87
L_own_101_n:
    s_waitcnt lgkmcnt(0)
    s_waitcnt lgkmcnt(0)
    v_mov_b32 v202, 64912
    v_mov_b32 v203, 1
    s_add_u32 s23, s23, 4
    s_mov_b64 exec, 1
    ds_add_u32 v202, v203
    s_mov_b64 exec, -1
    s_mov_b32 s98, 0
L_s4_102:
    ds_read_b32 v203, v202
    s_waitcnt lgkmcnt(0)
    v_readfirstlane_b32 s61, v203
    s_add_u32 s98, s98, 1
    s_cmp_ge_u32 s61, s23
    s_cbranch_scc1 L_s4_102_d
    s_cmp_lt_u32 s98, 0x100000
    s_cbranch_scc1 L_s4_102
L_s4_102_d:
    s_lshl_b32 s62, s6, 13
    s_add_u32 s62, s62, 32768
    s_add_u32 s63, s6, 1
    s_and_b32 s63, s63, 3
    s_lshl_b32 s63, s63, 11
    s_add_u32 s63, s63, s62
    v_add_u32 v200, s63, v1
    ds_read_b128 v[168:171], v200
    ds_read_b128 v[172:175], v200 offset:1024
    s_add_u32 s63, s6, 2
    s_and_b32 s63, s63, 3
    s_lshl_b32 s63, s63, 11
    s_add_u32 s63, s63, s62
    v_add_u32 v200, s63, v1
    ds_read_b128 v[176:179], v200
    ds_read_b128 v[180:183], v200 offset:1024
    s_add_u32 s63, s6, 3
    s_and_b32 s63, s63, 3
    s_lshl_b32 s63, s63, 11
    s_add_u32 s63, s63, s62
    v_add_u32 v200, s63, v1
    ds_read_b128 v[184:187], v200
    ds_read_b128 v[188:191], v200 offset:1024
    s_waitcnt lgkmcnt(0)
    v_add_f32 v160, v160, v168
    v_add_f32 v161, v161, v169
    v_add_f32 v162, v162, v170
    v_add_f32 v163, v163, v171
    v_add_f32 v164, v164, v172
    v_add_f32 v165, v165, v173
    v_add_f32 v166, v166, v174
    v_add_f32 v167, v167, v175
    v_add_f32 v176, v176, v184
    v_add_f32 v177, v177, v185
    v_add_f32 v178, v178, v186
    v_add_f32 v179, v179, v187
    v_add_f32 v180, v180, v188
    v_add_f32 v181, v181, v189
    v_add_f32 v182, v182, v190
    v_add_f32 v183, v183, v191
    v_add_f32 v160, v160, v176
    v_add_f32 v161, v161, v177
    v_add_f32 v162, v162, v178
    v_add_f32 v163, v163, v179
    v_add_f32 v164, v164, v180
    v_add_f32 v165, v165, v181
    v_add_f32 v166, v166, v182
    v_add_f32 v167, v167, v183
    v_cvt_pk_bf16_f32 v192, v160, v161
    v_cvt_pk_bf16_f32 v193, v162, v163
    v_cvt_pk_bf16_f32 v194, v164, v165
    v_cvt_pk_bf16_f32 v195, v166, v167
    s_nop 1
    v_permlane32_swap_b32 v192, v194
    v_permlane32_swap_b32 v193, v195
    s_waitcnt vmcnt(0)
    v_lshlrev_b32 v168, 16, v192
    v_and_b32 v169, 0xffff0000, v192
    v_lshlrev_b32 v170, 16, v193
    v_and_b32 v171, 0xffff0000, v193
    v_lshlrev_b32 v172, 16, v194
    v_and_b32 v173, 0xffff0000, v194
    v_lshlrev_b32 v174, 16, v195
    v_and_b32 v175, 0xffff0000, v195
    v_lshlrev_b32 v176, 16, v196
    v_and_b32 v177, 0xffff0000, v196
    v_lshlrev_b32 v178, 16, v197
    v_and_b32 v179, 0xffff0000, v197
    v_lshlrev_b32 v180, 16, v198
    v_and_b32 v181, 0xffff0000, v198
    v_lshlrev_b32 v182, 16, v199
    v_and_b32 v183, 0xffff0000, v199
    v_add_f32 v168, v168, v176
    v_add_f32 v169, v169, v177
    v_add_f32 v170, v170, v178
    v_add_f32 v171, v171, v179
    v_add_f32 v172, v172, v180
    v_add_f32 v173, v173, v181
    v_add_f32 v174, v174, v182
    v_add_f32 v175, v175, v183
    v_cvt_pk_bf16_f32 v192, v168, v169
    v_cvt_pk_bf16_f32 v193, v170, v171
    v_cvt_pk_bf16_f32 v194, v172, v173
    v_cvt_pk_bf16_f32 v195, v174, v175
    buffer_store_dwordx4 v[192:195], v6, s[44:47], s33 offen
    s_waitcnt vmcnt(0)
L_fin:
L_end2:
L_k2_end:
    s_endpgm
.section .rodata,"a"
.p2align 6
.amdhsa_kernel p1_conv_kernel
  .amdhsa_next_free_vgpr 256
  .amdhsa_next_free_sgpr 102
  .amdhsa_accum_offset 256
  .amdhsa_group_segment_fixed_size 0
  .amdhsa_kernarg_size 104
  .amdhsa_user_sgpr_count 2
  .amdhsa_user_sgpr_kernarg_segment_ptr 1
  .amdhsa_system_sgpr_workgroup_id_x 1
  .amdhsa_float_denorm_mode_32 3
  .amdhsa_float_denorm_mode_16_64 3
.end_amdhsa_kernel
.section .rodata,"a"
.p2align 6
.amdhsa_kernel interleave_layers__ssm_conv_h3__glu_gated_swiglu__prompt_kernel
  .amdhsa_next_free_vgpr 512
  .amdhsa_next_free_sgpr 102
  .amdhsa_accum_offset 256
  .amdhsa_group_segment_fixed_size 0
  .amdhsa_kernarg_size 104
  .amdhsa_user_sgpr_count 2
  .amdhsa_user_sgpr_kernarg_segment_ptr 1
  .amdhsa_system_sgpr_workgroup_id_x 1
  .amdhsa_float_denorm_mode_32 3
  .amdhsa_float_denorm_mode_16_64 3
.end_amdhsa_kernel
```
